```python
import torch

def _softmax(x, axis=-1):
    return torch.softmax(x, dim=axis)
def _gelu(x):
    return torch.nn.functional.gelu(x, approximate="tanh")
def _silu(x):
    return torch.nn.functional.silu(x)
def _sigmoid(x):
    return torch.sigmoid(x)
def _layernorm(x, axis=-1, eps=1e-5):
    m = x.mean(dim=axis, keepdim=True)
    v = x.var(dim=axis, keepdim=True, unbiased=False)
    return (x - m) / torch.sqrt(v + eps)
def _scatter_add(tgt, idx, src, axis=0):
    return tgt.clone().index_add_(axis, idx, src)
def _segment_sum(src, seg, n):
    out = torch.zeros((n,) + src.shape[1:], dtype=src.dtype)
    return out.index_add_(0, seg, src)
def _pad(x, pw):
    flat = tuple(v for pair in reversed(pw) for v in pair)
    return torch.nn.functional.pad(x, flat)

kernel_name = 'gated_mix__linear_kernel_hedgehog__mha_block__prompt'

def setup_inputs():

    _w = (lambda a: (lambda t: t.to(torch.bfloat16) if t.is_floating_point() else t)(torch.as_tensor(a)))
    def _A_setup():
        B, S, D, H = 1, 2048, 512, 32
        Dh = D // H
        return {
            "x": _w((lambda *s: torch.randn(*s, dtype=torch.bfloat16) * 0.05)(B, S, D)),
            "wqkv": _w((lambda *s: torch.randn(*s, dtype=torch.bfloat16) * 3.2)(D, 3 * D)),
            "w_phi": _w((lambda *s: torch.randn(*s, dtype=torch.bfloat16) * 3.2)(H, Dh, Dh) * (Dh ** -0.5)),
            "wo": _w((lambda *s: torch.randn(*s, dtype=torch.bfloat16) * 0.05)(D, D)),
        }
    _A_in = _A_setup()

    def _B_setup():
        B, S, D, H = 1, 2048, 512, 32
        return {
            "x": _w((lambda *s: torch.randn(*s, dtype=torch.bfloat16) * 0.05)(B, S, D)),
            "wqkv": _w((lambda *s: torch.randn(*s, dtype=torch.bfloat16) * 1.6)(D, 3 * D)),
            "wo": _w((lambda *s: torch.randn(*s, dtype=torch.bfloat16) * 0.05)(D, D)),
        }
    _B_in = _B_setup()

    return {
        "A_x": _A_in["x"],
        "A_wqkv": _A_in["wqkv"],
        "A_w_phi": _A_in["w_phi"],
        "A_wo": _A_in["wo"],
        "B_x": _B_in["x"],
        "B_wqkv": _B_in["wqkv"],
        "B_wo": _B_in["wo"],
        "gate_w": _w((lambda *s: torch.randn(*s, dtype=torch.bfloat16) * 0.05)(512) * 16.0),
    }

def reference(A_x, A_wqkv, A_w_phi, A_wo, B_x, B_wqkv, B_wo, gate_w):
    def _A_ref(x, wqkv, w_phi, wo):
        B, S, D = x.shape
        H = 32; Dh = D // H
        qkv = (lambda x, *d: x.permute(*d))((x @ wqkv).reshape(B, S, 3, H, Dh), 2, 0, 3, 1, 4)
        q, k, v = qkv[0], qkv[1], qkv[2]
        pq = torch.einsum("bhsd,hdf->bhsf", q, w_phi)
        pk = torch.einsum("bhsd,hdf->bhsf", k, w_phi)
        phi_q = torch.concatenate([_softmax(pq, axis=-1), _softmax(-pq, axis=-1)], axis=-1)
        phi_k = torch.concatenate([_softmax(pk, axis=-1), _softmax(-pk, axis=-1)], axis=-1)
        kv = torch.einsum("bhsf,bhsd->bhfd", phi_k, v)
        z  = torch.einsum("bhsf->bhf", phi_k)
        num = torch.einsum("bhqf,bhfd->bhqd", phi_q, kv)
        den = torch.einsum("bhqf,bhf->bhq", phi_q, z)[..., None] + 1e-6
        o = num / den
        return (lambda x, *d: x.permute(*d))(o, 0, 2, 1, 3).reshape(B, S, D) @ wo

    def _B_ref(x, wqkv, wo):
        B, S, D = x.shape
        H = 32
        Dh = D // H
        qkv = (lambda x, *d: x.permute(*d))((x @ wqkv).reshape(B, S, 3, H, Dh), 2, 0, 3, 1, 4)
        q, k, v = qkv[0], qkv[1], qkv[2]
        scores = torch.einsum("bhqd,bhkd->bhqk", q, k) * (Dh ** -0.5)
        p = _softmax(scores, axis=-1)
        o = torch.einsum("bhqk,bhkd->bhqd", p, v)
        return (lambda x, *d: x.permute(*d))(o, 0, 2, 1, 3).reshape(B, S, D) @ wo

    x = A_x
    g = _sigmoid((x * gate_w).sum(-1, keepdims=True))
    a = _A_ref(x, A_wqkv, A_w_phi, A_wo)
    b = _B_ref(x, B_wqkv, B_wo)
    return g * a + (1 - g) * b
```

```asm
; @launch grid=(256,1,1) block=(512,1,1) lds=163840
.amdgcn_target "amdgcn-amd-amdhsa--gfx950"
.text
.globl gated_mix__linear_kernel_hedgehog__mha_block__prompt_kernel
.p2align 8
.type gated_mix__linear_kernel_hedgehog__mha_block__prompt_kernel,@function
gated_mix__linear_kernel_hedgehog__mha_block__prompt_kernel:
    s_cmp_ge_u32 s2, 256
    s_cbranch_scc1 L_END
    s_load_dwordx8 s[4:11], s[0:1], 0
    s_load_dwordx8 s[12:19], s[0:1], 32
    s_load_dwordx4 s[20:23], s[0:1], 64
    s_load_dwordx2 s[24:25], s[0:1], 80
    s_getpc_b64 s[26:27]
L_PC:
    v_lshrrev_b32 v64, 6, v0
    v_and_b32 v1, 63, v0
    s_and_b32 s69, s2, 7
    v_readfirstlane_b32 s68, v64
    s_lshr_b32 s70, s2, 3
    s_and_b32 s83, s70, 1
    s_lshr_b32 s87, s2, 4
    s_mov_b32 s3, s69
    s_lshl_b32 s72, s83, 2
    s_add_u32 s71, s87, s69
    s_add_u32 s71, s71, s72
    v_lshrrev_b32 v64, 3, v1
    v_and_b32 v65, 7, v1
    v_lshrrev_b32 v66, 4, v1
    v_xor_b32 v67, v65, v66
    v_lshlrev_b32 v67, 4, v67
    v_lshl_add_u32 v9, v64, 10, v67
    v_xor_b32 v10, 64, v9
    v_add_u32 v10, 7168, v10
    v_and_b32 v66, 1, v66
    v_lshlrev_b32 v66, 2, v66
    v_xor_b32 v67, v65, v66
    v_lshlrev_b32 v67, 4, v67
    v_mul_u32_u24 v11, 3072, v64
    v_add_u32 v11, v11, v67
    v_lshl_add_u32 v6, v64, 10, v67
    s_lshl_b32 s76, s87, 17
    s_lshl_b32 s72, s68, 14
    s_add_u32 s76, s76, s72
    s_lshl_b32 s77, s3, 7
    s_mul_i32 s72, s68, 24576
    s_add_u32 s77, s77, s72
    s_lshl_b32 s72, s83, 10
    s_add_u32 s77, s77, s72
    s_lshl_b32 s78, s68, 11
    s_lshl_b32 s79, s68, 10
    v_lshlrev_b32 v2, 4, v1
    s_mov_b32 s30, 0x200000
    s_mov_b32 s31, 0x20000
    s_mov_b32 s34, 0x180000
    s_mov_b32 s35, 0x20000
    s_mov_b32 s46, 0x180000
    s_mov_b32 s47, 0x20000
    s_cmp_eq_u32 s83, 0
    s_waitcnt lgkmcnt(0)
    s_mov_b64 s[28:29], s[4:5]
    s_mov_b64 s[32:33], s[14:15]
    s_cselect_b32 s44, s6, s14
    s_cselect_b32 s45, s7, s15
    s_add_u32 s12, s71, 0
    s_and_b32 s12, s12, 7
    s_lshl_b32 s13, s12, 7
    s_add_u32 m0, s78, 0
    s_add_u32 s13, s13, s76
    buffer_load_dwordx4 v9, s[28:31], s13 offen lds
    buffer_load_dwordx4 v10, s[28:31], s13 offen offset:1024 lds
    s_mul_i32 s12, s12, 196608
    s_add_u32 m0, s79, 16384
    s_add_u32 s12, s12, s77
    buffer_load_dwordx4 v11, s[32:35], s12 offen lds
    s_add_u32 m0, s79, 23552
    s_nop 0
    buffer_load_dwordx4 v11, s[44:47], s12 offen offset:1024 lds
    s_mov_b32 s40, s24
    s_mov_b32 s41, s25
    s_mov_b32 s42, 0xc20000
    s_mov_b32 s43, 0x20000
    s_cmp_lg_u32 s2, 0
    s_cbranch_scc1 L_NOZERO
    v_mov_b64 v[68:69], 0
    v_mov_b64 v[70:71], 0
    s_lshl_b32 s72, s68, 11
    s_add_u32 s72, s72, 0xc1a000
    buffer_store_dwordx4 v[68:71], v2, s[40:43], s72 offen sc1
    buffer_store_dwordx4 v[68:71], v2, s[40:43], s72 offen offset:1024 sc1
    s_cmp_lg_u32 s68, 0
    s_cbranch_scc1 L_NOZERO
    v_lshlrev_b32 v64, 8, v1
    s_mov_b32 s72, 0xc10000
    s_mov_b64 exec, 0xff
    buffer_store_dword v68, v64, s[40:43], s72 offen sc1
    s_mov_b64 exec, -1
    s_mov_b32 s72, 0xc18000
    buffer_store_dwordx4 v[68:71], v2, s[40:43], s72 offen sc1
L_NOZERO:
    s_mov_b32 s64, s8
    s_mov_b32 s65, s9
    s_mov_b32 s66, 0x4000
    s_mov_b32 s67, 0x20000
    s_lshl_b32 s72, s68, 8
    s_add_u32 m0, s72, 131072
    s_lshl_b32 s73, s3, 11
    s_add_u32 s73, s73, s72
    v_lshlrev_b32 v64, 2, v1
    buffer_load_dword v64, s[64:67], s73 offen lds
    s_barrier
    s_add_u32 s12, s71, 1
    s_and_b32 s12, s12, 7
    s_lshl_b32 s13, s12, 7
    s_add_u32 m0, s78, 32768
    s_add_u32 s13, s13, s76
    buffer_load_dwordx4 v9, s[28:31], s13 offen lds
    buffer_load_dwordx4 v10, s[28:31], s13 offen offset:1024 lds
    s_mul_i32 s12, s12, 196608
    s_add_u32 m0, s79, 49152
    s_add_u32 s12, s12, s77
    buffer_load_dwordx4 v11, s[32:35], s12 offen lds
    s_add_u32 m0, s79, 56320
    s_nop 0
    buffer_load_dwordx4 v11, s[44:47], s12 offen offset:1024 lds
    s_mov_b32 s36, s6
    s_mov_b32 s37, s7
    s_mov_b32 s38, 0x180000
    s_mov_b32 s39, 0x20000
    s_mov_b32 s56, s10
    s_mov_b32 s57, s11
    s_mov_b32 s58, 0x80000
    s_mov_b32 s59, 0x20000
    s_mov_b32 s60, s16
    s_mov_b32 s61, s17
    s_mov_b32 s62, 0x80000
    s_mov_b32 s63, 0x20000
    s_mov_b32 s64, s20
    s_mov_b32 s65, s21
    s_mov_b32 s66, 0x200000
    s_mov_b32 s67, 0x20000
    s_mov_b32 s52, s22
    s_mov_b32 s53, s23
    s_mov_b32 s54, 0x100
    s_mov_b32 s55, 0x20000
    s_mov_b32 s48, s18
    s_mov_b32 s49, s19
    s_mov_b32 s50, 0x400
    s_mov_b32 s51, 0x20000
    s_and_b32 s95, s68, 3
    s_lshr_b32 s73, s68, 2
    s_lshl_b32 s72, s95, 12
    v_and_b32 v64, 31, v1
    v_lshrrev_b32 v65, 5, v1
    v_bfe_u32 v66, v1, 1, 3
    v_xor_b32 v66, v66, v65
    v_lshlrev_b32 v64, 7, v64
    v_add_u32 v64, s72, v64
    v_xor_b32 v67, 0, v66
    v_lshl_add_u32 v80, v67, 4, v64
    v_add_u32 v84, 0x10000, v80
    v_add_u32 v88, 0x20000, v80
    v_xor_b32 v67, 2, v66
    v_lshl_add_u32 v81, v67, 4, v64
    v_add_u32 v85, 0x10000, v81
    v_add_u32 v89, 0x20000, v81
    v_xor_b32 v67, 4, v66
    v_lshl_add_u32 v82, v67, 4, v64
    v_add_u32 v86, 0x10000, v82
    v_add_u32 v90, 0x20000, v82
    v_xor_b32 v67, 6, v66
    v_lshl_add_u32 v83, v67, 4, v64
    v_add_u32 v87, 0x10000, v83
    v_add_u32 v91, 0x20000, v83
    v_bfe_u32 v64, v1, 2, 2
    v_lshrrev_b32 v66, 1, v64
    v_lshlrev_b32 v66, 6, v66
    v_lshl_add_u32 v66, v64, 7, v66
    v_bfe_u32 v64, v1, 4, 1
    v_lshl_add_u32 v66, v64, 5, v66
    v_and_b32 v64, 3, v1
    v_lshl_add_u32 v66, v64, 3, v66
    s_lshl_b32 s72, s73, 6
    v_lshl_add_u32 v92, v65, 10, v66
    v_xor_b32 v92, s72, v92
    v_add_u32 v93, 0x10000, v92
    v_add_u32 v94, 0x20000, v92
    s_lshr_b32 s10, s68, 1
    s_and_b32 s11, s68, 1
    s_and_b32 s72, s10, 1
    s_lshl_b32 s74, s72, 14
    s_add_u32 s74, s74, 131072
    s_lshl_b32 s75, s72, 16
    s_add_u32 s75, s75, 2048
    s_cmp_lt_u32 s10, 2
    s_cselect_b32 s92, s74, s75
    v_lshl_add_u32 v7, v65, 9, v66
    v_add_u32 v7, s92, v7
    v_xor_b32 v8, 64, v7
    s_mov_b32 s80, 0x3fb8aa3b
    s_mov_b32 s81, 0x3fb8aa3b
    s_mov_b32 s82, 0xbfb8aa3b
    s_mov_b32 s84, 0x3eb8aa3b
    s_mov_b32 s0, 0xffff
    s_mov_b32 s1, 0xffff
    s_lshl_b32 s88, s69, 2
    s_and_b32 s72, s70, 3
    s_add_u32 s88, s88, s72
    s_lshr_b32 s89, s70, 2
    s_mov_b32 s4, s89
    s_lshl_b32 s5, s88, 1
    s_add_u32 s5, s5, s11
    s_lshl_b32 s90, s89, 3
    s_lshl_b32 s72, s95, 1
    s_add_u32 s90, s90, s72
    s_add_u32 s90, s90, s73
    s_lshl_b32 s72, s73, 16
    v_add_u32 v3, s72, v2
    v_and_b32 v64, 15, v1
    v_lshl_add_u32 v64, v65, 4, v64
    v_lshl_add_u32 v4, v64, 4, s72
    v_mov_b32 v5, 0xdddddddd
    s_lshl_b32 s85, s95, 11
    s_add_u32 s85, s85, s72
    s_lshl_b32 s93, s68, 16
    s_lshl_b32 s72, s4, 7
    s_add_u32 s93, s93, s72
    s_getreg_b32 s6, hwreg(HW_REG_XCC_ID, 0, 4)
    s_add_u32 s6, s6, 1
    s_lshl_b32 s9, s69, 7
    s_add_u32 s9, s9, 0xc18000
    s_lshl_b32 s7, s70, 2
    s_add_u32 s7, s7, s9
    s_lshl_b32 s94, s88, 16
    s_lshl_b32 s72, s68, 13
    s_add_u32 s94, s94, s72
    s_add_u32 s94, s94, 0xa00000
    s_lshl_b32 s100, s89, 8
    s_lshr_b32 s72, s88, 1
    s_lshl_b32 s72, s72, 3
    s_add_u32 s72, s72, s68
    s_lshl_b32 s72, s72, 1
    s_add_u32 s100, s100, s72
    s_lshl_b32 s101, s3, 1
    s_add_u32 s101, s101, s73
    s_lshl_b32 s101, s101, 18
    s_lshl_b32 s72, s87, 2
    s_add_u32 s72, s72, s95
    s_lshl_b32 s72, s72, 11
    s_add_u32 s101, s101, s72
    v_and_b32 v64, 15, v1
    v_lshlrev_b32 v64, 3, v64
    v_lshl_add_u32 v64, v65, 7, v64
    s_lshl_b32 s72, s73, 10
    s_add_u32 s72, s72, 131072
    v_add_u32 v78, s72, v64
    v_bfe_u32 v64, v1, 4, 1
    v_mul_u32_u24 v79, 0x8000, v64
    v_lshl_or_b32 v79, v79, 16, v79
    v_bfe_u32 v64, v1, 2, 1
    v_bfe_u32 v67, v1, 3, 1
    v_and_b32 v66, 0x33, v1
    v_lshl_or_b32 v66, v64, 3, v66
    v_lshl_or_b32 v66, v67, 2, v66
    v_lshlrev_b32 v12, 4, v66
    v_bfe_u32 v64, v1, 4, 1
    v_and_b32 v66, 0xffff, v4
    v_lshl_add_u32 v13, v64, 17, v66
    s_cmp_lg_u32 s68, 3
    s_cbranch_scc1 Lwt1
    s_lshl_b32 s72, s2, 11
    v_lshlrev_b32 v64, 7, v1
    s_mov_b64 exec, 0xffff
    buffer_load_dword v14, v64, s[56:59], s72 offen
    buffer_load_dword v14, v64, s[60:63], s72 offen
    s_mov_b64 exec, -1
Lwt1:
    s_cmp_eq_u32 s83, 0
    s_cbranch_scc0 L_T1
    s_waitcnt vmcnt(4)
    s_barrier
    ds_read_b128 v[128:131], v80 offset:0
    ds_read_b64_tr_b16 v[96:97], v92 offset:16384
    ds_read_b64_tr_b16 v[98:99], v92 offset:16896
    ds_read_b64_tr_b16 v[100:101], v92 offset:24576
    ds_read_b64_tr_b16 v[102:103], v92 offset:25088
    ds_read_b128 v[132:135], v81 offset:0
    ds_read_b64_tr_b16 v[104:105], v92 offset:18432
    ds_read_b64_tr_b16 v[106:107], v92 offset:18944
    ds_read_b64_tr_b16 v[108:109], v92 offset:26624
    ds_read_b64_tr_b16 v[110:111], v92 offset:27136
    ds_read_b128 v[136:139], v82 offset:0
    ds_read_b64_tr_b16 v[112:113], v92 offset:20480
    ds_read_b64_tr_b16 v[114:115], v92 offset:20992
    ds_read_b64_tr_b16 v[116:117], v92 offset:28672
    ds_read_b64_tr_b16 v[118:119], v92 offset:29184
    ds_read_b64_tr_b16 v[120:121], v78 offset:0
    ds_read_b64_tr_b16 v[122:123], v78 offset:256
    ds_read_b64_tr_b16 v[124:125], v78 offset:512
    ds_read_b64_tr_b16 v[126:127], v78 offset:768
    s_add_u32 s12, s71, 2
    s_and_b32 s12, s12, 7
    s_lshl_b32 s13, s12, 7
    s_add_u32 m0, s78, 65536
    s_add_u32 s13, s13, s76
    buffer_load_dwordx4 v9, s[28:31], s13 offen lds
    buffer_load_dwordx4 v10, s[28:31], s13 offen offset:1024 lds
    s_waitcnt lgkmcnt(14)
    v_mfma_f32_32x32x16_bf16 v[32:47], v[96:99], v[128:131], 0
    ds_read_b128 v[140:143], v83 offset:0
    ds_read_b64_tr_b16 v[96:97], v92 offset:22528
    ds_read_b64_tr_b16 v[98:99], v92 offset:23040
    v_mfma_f32_32x32x16_bf16 v[48:63], v[100:103], v[128:131], 0
    ds_read_b64_tr_b16 v[100:101], v92 offset:30720
    ds_read_b64_tr_b16 v[102:103], v92 offset:31232
    s_mul_i32 s12, s12, 196608
    s_add_u32 m0, s79, 81920
    s_add_u32 s12, s12, s77
    buffer_load_dwordx4 v11, s[32:35], s12 offen lds
    s_waitcnt lgkmcnt(14)
    v_mfma_f32_32x32x16_bf16 v[32:47], v[104:107], v[132:135], v[32:47]
    v_mfma_f32_32x32x16_bf16 v[48:63], v[108:111], v[132:135], v[48:63]
    s_add_u32 m0, s79, 89088
    s_nop 0
    buffer_load_dwordx4 v11, s[44:47], s12 offen offset:1024 lds
    s_waitcnt lgkmcnt(0)
    s_waitcnt vmcnt(4)
    s_barrier
    ds_read_b128 v[144:147], v80 offset:32768
    ds_read_b64_tr_b16 v[104:105], v92 offset:49152
    ds_read_b64_tr_b16 v[106:107], v92 offset:49664
    ds_read_b64_tr_b16 v[108:109], v92 offset:57344
    ds_read_b64_tr_b16 v[110:111], v92 offset:57856
    v_mfma_f32_32x32x16_bf16 v[32:47], v[112:115], v[136:139], v[32:47]
    ds_read_b128 v[148:151], v81 offset:32768
    ds_read_b64_tr_b16 v[112:113], v92 offset:51200
    ds_read_b64_tr_b16 v[114:115], v92 offset:51712
    v_mfma_f32_32x32x16_bf16 v[48:63], v[116:119], v[136:139], v[48:63]
    ds_read_b64_tr_b16 v[116:117], v92 offset:59392
    ds_read_b64_tr_b16 v[118:119], v92 offset:59904
    s_add_u32 s12, s71, 3
    s_and_b32 s12, s12, 7
    s_lshl_b32 s13, s12, 7
    s_add_u32 m0, s78, 98304
    s_add_u32 s13, s13, s76
    buffer_load_dwordx4 v9, s[28:31], s13 offen lds
    v_mfma_f32_32x32x16_bf16 v[32:47], v[96:99], v[140:143], v[32:47]
    ds_read_b128 v[152:155], v82 offset:32768
    ds_read_b64_tr_b16 v[96:97], v92 offset:53248
    ds_read_b64_tr_b16 v[98:99], v92 offset:53760
    v_mfma_f32_32x32x16_bf16 v[48:63], v[100:103], v[140:143], v[48:63]
    ds_read_b64_tr_b16 v[100:101], v92 offset:61440
    ds_read_b64_tr_b16 v[102:103], v92 offset:61952
    buffer_load_dwordx4 v10, s[28:31], s13 offen offset:1024 lds
    s_or_b32 s72, s2, s68
    s_cmp_lg_u32 s72, 0
    s_cbranch_scc1 L_NOGUARD
    v_mov_b32 v65, 1
    s_mov_b64 exec, 1
    buffer_store_dword v65, off, s[52:55], 0 sc1
    s_mov_b64 exec, -1
L_NOGUARD:
    s_waitcnt lgkmcnt(10)
    v_mfma_f32_32x32x16_bf16 v[32:47], v[104:107], v[144:147], v[32:47]
    ds_read_b128 v[156:159], v83 offset:32768
    ds_read_b64_tr_b16 v[104:105], v92 offset:55296
    ds_read_b64_tr_b16 v[106:107], v92 offset:55808
    v_mfma_f32_32x32x16_bf16 v[48:63], v[108:111], v[144:147], v[48:63]
    ds_read_b64_tr_b16 v[108:109], v92 offset:63488
    ds_read_b64_tr_b16 v[110:111], v92 offset:64000
    s_mul_i32 s12, s12, 196608
    s_add_u32 m0, s79, 114688
    s_add_u32 s12, s12, s77
    buffer_load_dwordx4 v11, s[32:35], s12 offen lds
    s_waitcnt lgkmcnt(10)
    v_mfma_f32_32x32x16_bf16 v[32:47], v[112:115], v[148:151], v[32:47]
    v_mfma_f32_32x32x16_bf16 v[48:63], v[116:119], v[148:151], v[48:63]
    s_add_u32 m0, s79, 121856
    s_nop 0
    buffer_load_dwordx4 v11, s[44:47], s12 offen offset:1024 lds
    s_waitcnt lgkmcnt(0)
    s_waitcnt vmcnt(4)
    s_barrier
    ds_read_b128 v[160:163], v84 offset:0
    ds_read_b64_tr_b16 v[112:113], v93 offset:16384
    ds_read_b64_tr_b16 v[114:115], v93 offset:16896
    ds_read_b64_tr_b16 v[116:117], v93 offset:24576
    ds_read_b64_tr_b16 v[118:119], v93 offset:25088
    v_mfma_f32_32x32x16_bf16 v[32:47], v[96:99], v[152:155], v[32:47]
    ds_read_b128 v[164:167], v85 offset:0
    ds_read_b64_tr_b16 v[96:97], v93 offset:18432
    ds_read_b64_tr_b16 v[98:99], v93 offset:18944
    v_mfma_f32_32x32x16_bf16 v[48:63], v[100:103], v[152:155], v[48:63]
    ds_read_b64_tr_b16 v[100:101], v93 offset:26624
    ds_read_b64_tr_b16 v[102:103], v93 offset:27136
    s_add_u32 s12, s71, 4
    s_and_b32 s12, s12, 7
    s_lshl_b32 s13, s12, 7
    s_add_u32 m0, s78, 131072
    s_add_u32 s13, s13, s76
    buffer_load_dwordx4 v9, s[28:31], s13 offen lds
    v_mfma_f32_32x32x16_bf16 v[32:47], v[104:107], v[156:159], v[32:47]
    ds_read_b128 v[168:171], v86 offset:0
    ds_read_b64_tr_b16 v[104:105], v93 offset:20480
    ds_read_b64_tr_b16 v[106:107], v93 offset:20992
    v_mfma_f32_32x32x16_bf16 v[48:63], v[108:111], v[156:159], v[48:63]
    ds_read_b64_tr_b16 v[108:109], v93 offset:28672
    ds_read_b64_tr_b16 v[110:111], v93 offset:29184
    buffer_load_dwordx4 v10, s[28:31], s13 offen offset:1024 lds
    v_xor_b32 v120, v79, v120
    v_xor_b32 v121, v79, v121
    v_xor_b32 v122, v79, v122
    v_xor_b32 v123, v79, v123
    v_xor_b32 v124, v79, v124
    v_xor_b32 v125, v79, v125
    v_xor_b32 v126, v79, v126
    v_xor_b32 v127, v79, v127
    s_waitcnt lgkmcnt(10)
    v_mfma_f32_32x32x16_bf16 v[32:47], v[112:115], v[160:163], v[32:47]
    ds_read_b128 v[172:175], v87 offset:0
    ds_read_b64_tr_b16 v[112:113], v93 offset:22528
    ds_read_b64_tr_b16 v[114:115], v93 offset:23040
    v_mfma_f32_32x32x16_bf16 v[48:63], v[116:119], v[160:163], v[48:63]
    ds_read_b64_tr_b16 v[116:117], v93 offset:30720
    ds_read_b64_tr_b16 v[118:119], v93 offset:31232
    s_mul_i32 s12, s12, 196608
    s_add_u32 m0, s79, 147456
    s_add_u32 s12, s12, s77
    buffer_load_dwordx4 v11, s[32:35], s12 offen lds
    s_waitcnt lgkmcnt(10)
    v_mfma_f32_32x32x16_bf16 v[32:47], v[96:99], v[164:167], v[32:47]
    v_mfma_f32_32x32x16_bf16 v[48:63], v[100:103], v[164:167], v[48:63]
    s_add_u32 m0, s79, 154624
    s_nop 0
    buffer_load_dwordx4 v11, s[44:47], s12 offen offset:1024 lds
    s_waitcnt lgkmcnt(0)
    s_waitcnt vmcnt(4)
    s_barrier
    ds_read_b128 v[176:179], v84 offset:32768
    ds_read_b64_tr_b16 v[96:97], v93 offset:49152
    ds_read_b64_tr_b16 v[98:99], v93 offset:49664
    ds_read_b64_tr_b16 v[100:101], v93 offset:57344
    ds_read_b64_tr_b16 v[102:103], v93 offset:57856
    v_mfma_f32_32x32x16_bf16 v[32:47], v[104:107], v[168:171], v[32:47]
    ds_read_b128 v[180:183], v85 offset:32768
    ds_read_b64_tr_b16 v[104:105], v93 offset:51200
    ds_read_b64_tr_b16 v[106:107], v93 offset:51712
    v_mfma_f32_32x32x16_bf16 v[48:63], v[108:111], v[168:171], v[48:63]
    ds_read_b64_tr_b16 v[108:109], v93 offset:59392
    ds_read_b64_tr_b16 v[110:111], v93 offset:59904
    s_add_u32 s12, s71, 5
    s_and_b32 s12, s12, 7
    s_lshl_b32 s13, s12, 7
    s_add_u32 m0, s78, 0
    s_add_u32 s13, s13, s76
    buffer_load_dwordx4 v9, s[28:31], s13 offen lds
    v_mfma_f32_32x32x16_bf16 v[32:47], v[112:115], v[172:175], v[32:47]
    ds_read_b128 v[184:187], v86 offset:32768
    ds_read_b64_tr_b16 v[112:113], v93 offset:53248
    ds_read_b64_tr_b16 v[114:115], v93 offset:53760
    v_mfma_f32_32x32x16_bf16 v[48:63], v[116:119], v[172:175], v[48:63]
    ds_read_b64_tr_b16 v[116:117], v93 offset:61440
    ds_read_b64_tr_b16 v[118:119], v93 offset:61952
    buffer_load_dwordx4 v10, s[28:31], s13 offen offset:1024 lds
    v_bfe_u32 v64, v1, 2, 1
    v_lshrrev_b32 v65, 5, v1
    v_bfe_u32 v66, v1, 3, 1
    v_bfe_u32 v67, v1, 1, 1
    v_lshl_add_u32 v66, v66, 1, v67
    v_and_b32 v67, 1, v1
    v_lshlrev_b32 v67, 4, v67
    v_mov_b32 v69, 0x3f80
    v_cmp_eq_u32 vcc, v64, v65
    v_lshlrev_b32 v67, v67, v69
    v_bfe_u32 v64, v1, 4, 1
    v_cndmask_b32 v67, 0, v67, vcc
    v_lshl_add_u32 v66, v64, 2, v66
    s_waitcnt lgkmcnt(10)
    v_mfma_f32_32x32x16_bf16 v[32:47], v[96:99], v[176:179], v[32:47]
    ds_read_b128 v[188:191], v87 offset:32768
    ds_read_b64_tr_b16 v[96:97], v93 offset:55296
    ds_read_b64_tr_b16 v[98:99], v93 offset:55808
    v_mfma_f32_32x32x16_bf16 v[48:63], v[100:103], v[176:179], v[48:63]
    ds_read_b64_tr_b16 v[100:101], v93 offset:63488
    ds_read_b64_tr_b16 v[102:103], v93 offset:64000
    s_mul_i32 s12, s12, 196608
    s_add_u32 m0, s79, 16384
    s_add_u32 s12, s12, s77
    buffer_load_dwordx4 v11, s[32:35], s12 offen lds
    s_waitcnt lgkmcnt(10)
    v_mfma_f32_32x32x16_bf16 v[32:47], v[104:107], v[180:183], v[32:47]
    v_mfma_f32_32x32x16_bf16 v[48:63], v[108:111], v[180:183], v[48:63]
    s_add_u32 m0, s79, 23552
    s_nop 0
    buffer_load_dwordx4 v11, s[44:47], s12 offen offset:1024 lds
    s_waitcnt lgkmcnt(0)
    s_waitcnt vmcnt(4)
    s_barrier
    ds_read_b128 v[192:195], v88 offset:0
    ds_read_b64_tr_b16 v[104:105], v94 offset:16384
    ds_read_b64_tr_b16 v[106:107], v94 offset:16896
    ds_read_b64_tr_b16 v[108:109], v94 offset:24576
    ds_read_b64_tr_b16 v[110:111], v94 offset:25088
    v_mfma_f32_32x32x16_bf16 v[32:47], v[112:115], v[184:187], v[32:47]
    ds_read_b128 v[196:199], v89 offset:0
    ds_read_b64_tr_b16 v[112:113], v94 offset:18432
    ds_read_b64_tr_b16 v[114:115], v94 offset:18944
    v_mfma_f32_32x32x16_bf16 v[48:63], v[116:119], v[184:187], v[48:63]
    ds_read_b64_tr_b16 v[116:117], v94 offset:26624
    ds_read_b64_tr_b16 v[118:119], v94 offset:27136
    s_add_u32 s12, s71, 6
    s_and_b32 s12, s12, 7
    s_lshl_b32 s13, s12, 7
    s_add_u32 m0, s78, 32768
    s_add_u32 s13, s13, s76
    buffer_load_dwordx4 v9, s[28:31], s13 offen lds
    v_mfma_f32_32x32x16_bf16 v[32:47], v[96:99], v[188:191], v[32:47]
    ds_read_b128 v[200:203], v90 offset:0
    ds_read_b64_tr_b16 v[96:97], v94 offset:20480
    ds_read_b64_tr_b16 v[98:99], v94 offset:20992
    v_mfma_f32_32x32x16_bf16 v[48:63], v[100:103], v[188:191], v[48:63]
    ds_read_b64_tr_b16 v[100:101], v94 offset:28672
    ds_read_b64_tr_b16 v[102:103], v94 offset:29184
    buffer_load_dwordx4 v10, s[28:31], s13 offen offset:1024 lds
    v_cmp_eq_u32 vcc, 0, v66
    v_cmp_eq_u32 s[96:97], 1, v66
    s_nop 0
    v_cndmask_b32 v72, 0, v67, vcc
    v_cndmask_b32 v73, 0, v67, s[96:97]
    v_cmp_eq_u32 vcc, 2, v66
    v_cmp_eq_u32 s[96:97], 3, v66
    s_nop 0
    v_cndmask_b32 v74, 0, v67, vcc
    v_cndmask_b32 v75, 0, v67, s[96:97]
    v_cmp_eq_u32 vcc, 4, v66
    v_cmp_eq_u32 s[96:97], 5, v66
    s_nop 0
    v_cndmask_b32 v76, 0, v67, vcc
    v_cndmask_b32 v77, 0, v67, s[96:97]
    v_cmp_eq_u32 vcc, 6, v66
    v_cmp_eq_u32 s[96:97], 7, v66
    s_nop 0
    v_cndmask_b32 v78, 0, v67, vcc
    v_cndmask_b32 v79, 0, v67, s[96:97]
    s_lshr_b32 s72, s68, 2
    s_lshl_b32 s72, s72, 16
    s_lshl_b32 s73, s95, 12
    s_add_u32 s72, s72, s73
    s_add_u32 s72, s72, 32768
    v_add_u32 v12, s72, v2
    v_xor_b32 v13, 256, v12
    s_waitcnt lgkmcnt(10)
    v_mfma_f32_32x32x16_bf16 v[32:47], v[104:107], v[192:195], v[32:47]
    ds_read_b128 v[204:207], v91 offset:0
    ds_read_b64_tr_b16 v[104:105], v94 offset:22528
    ds_read_b64_tr_b16 v[106:107], v94 offset:23040
    v_mfma_f32_32x32x16_bf16 v[48:63], v[108:111], v[192:195], v[48:63]
    ds_read_b64_tr_b16 v[108:109], v94 offset:30720
    ds_read_b64_tr_b16 v[110:111], v94 offset:31232
    s_mul_i32 s12, s12, 196608
    s_add_u32 m0, s79, 49152
    s_add_u32 s12, s12, s77
    buffer_load_dwordx4 v11, s[32:35], s12 offen lds
    s_waitcnt lgkmcnt(10)
    v_mfma_f32_32x32x16_bf16 v[32:47], v[112:115], v[196:199], v[32:47]
    v_mfma_f32_32x32x16_bf16 v[48:63], v[116:119], v[196:199], v[48:63]
    s_add_u32 m0, s79, 56320
    s_nop 0
    buffer_load_dwordx4 v11, s[44:47], s12 offen offset:1024 lds
    s_waitcnt lgkmcnt(0)
    s_waitcnt vmcnt(4)
    s_barrier
    ds_read_b128 v[208:211], v80 offset:0
    ds_read_b64_tr_b16 v[112:113], v92 offset:16384
    ds_read_b64_tr_b16 v[114:115], v92 offset:16896
    ds_read_b64_tr_b16 v[116:117], v92 offset:24576
    ds_read_b64_tr_b16 v[118:119], v92 offset:25088
    v_mfma_f32_32x32x16_bf16 v[32:47], v[96:99], v[200:203], v[32:47]
    ds_read_b128 v[212:215], v81 offset:0
    ds_read_b64_tr_b16 v[96:97], v92 offset:18432
    ds_read_b64_tr_b16 v[98:99], v92 offset:18944
    v_mfma_f32_32x32x16_bf16 v[48:63], v[100:103], v[200:203], v[48:63]
    ds_read_b64_tr_b16 v[100:101], v92 offset:26624
    ds_read_b64_tr_b16 v[102:103], v92 offset:27136
    s_add_u32 s12, s71, 7
    s_and_b32 s12, s12, 7
    s_lshl_b32 s13, s12, 7
    s_add_u32 m0, s78, 65536
    s_add_u32 s13, s13, s76
    buffer_load_dwordx4 v9, s[28:31], s13 offen lds
    v_mfma_f32_32x32x16_bf16 v[32:47], v[104:107], v[204:207], v[32:47]
    ds_read_b128 v[216:219], v82 offset:0
    ds_read_b64_tr_b16 v[104:105], v92 offset:20480
    ds_read_b64_tr_b16 v[106:107], v92 offset:20992
    v_mfma_f32_32x32x16_bf16 v[48:63], v[108:111], v[204:207], v[48:63]
    ds_read_b64_tr_b16 v[108:109], v92 offset:28672
    ds_read_b64_tr_b16 v[110:111], v92 offset:29184
    buffer_load_dwordx4 v10, s[28:31], s13 offen offset:1024 lds
    s_waitcnt lgkmcnt(10)
    v_mfma_f32_32x32x16_bf16 v[32:47], v[112:115], v[208:211], v[32:47]
    ds_read_b128 v[220:223], v83 offset:0
    ds_read_b64_tr_b16 v[112:113], v92 offset:22528
    ds_read_b64_tr_b16 v[114:115], v92 offset:23040
    v_mfma_f32_32x32x16_bf16 v[48:63], v[116:119], v[208:211], v[48:63]
    ds_read_b64_tr_b16 v[116:117], v92 offset:30720
    ds_read_b64_tr_b16 v[118:119], v92 offset:31232
    s_mul_i32 s12, s12, 196608
    s_add_u32 m0, s79, 81920
    s_add_u32 s12, s12, s77
    buffer_load_dwordx4 v11, s[32:35], s12 offen lds
    s_waitcnt lgkmcnt(10)
    v_mfma_f32_32x32x16_bf16 v[32:47], v[96:99], v[212:215], v[32:47]
    v_mfma_f32_32x32x16_bf16 v[48:63], v[100:103], v[212:215], v[48:63]
    s_add_u32 m0, s79, 89088
    s_nop 0
    buffer_load_dwordx4 v11, s[44:47], s12 offen offset:1024 lds
    s_waitcnt lgkmcnt(0)
    s_waitcnt vmcnt(4)
    s_barrier
    ds_read_b128 v[224:227], v80 offset:32768
    ds_read_b64_tr_b16 v[96:97], v92 offset:49152
    ds_read_b64_tr_b16 v[98:99], v92 offset:49664
    ds_read_b64_tr_b16 v[100:101], v92 offset:57344
    ds_read_b64_tr_b16 v[102:103], v92 offset:57856
    v_mfma_f32_32x32x16_bf16 v[32:47], v[104:107], v[216:219], v[32:47]
    ds_read_b128 v[228:231], v81 offset:32768
    ds_read_b64_tr_b16 v[104:105], v92 offset:51200
    ds_read_b64_tr_b16 v[106:107], v92 offset:51712
    v_mfma_f32_32x32x16_bf16 v[48:63], v[108:111], v[216:219], v[48:63]
    ds_read_b64_tr_b16 v[108:109], v92 offset:59392
    ds_read_b64_tr_b16 v[110:111], v92 offset:59904
    s_add_u32 s12, s71, 0
    s_and_b32 s12, s12, 7
    s_mul_i32 s12, s12, 196608
    s_add_u32 s12, s12, s77
    s_add_u32 m0, s79, 98304
    s_add_u32 s12, s12, 2048
    buffer_load_dwordx4 v11, s[36:39], s12 offen lds
    v_mfma_f32_32x32x16_bf16 v[32:47], v[112:115], v[220:223], v[32:47]
    ds_read_b128 v[232:235], v82 offset:32768
    ds_read_b64_tr_b16 v[112:113], v92 offset:53248
    ds_read_b64_tr_b16 v[114:115], v92 offset:53760
    v_mfma_f32_32x32x16_bf16 v[48:63], v[116:119], v[220:223], v[48:63]
    ds_read_b64_tr_b16 v[116:117], v92 offset:61440
    ds_read_b64_tr_b16 v[118:119], v92 offset:61952
    s_add_u32 s12, s71, 1
    s_and_b32 s12, s12, 7
    s_mul_i32 s12, s12, 196608
    s_add_u32 s12, s12, s77
    s_add_u32 m0, s79, 106496
    s_add_u32 s12, s12, 2048
    buffer_load_dwordx4 v11, s[36:39], s12 offen lds
    s_cmp_lg_u32 s68, 0
    s_cbranch_scc1 Lpi2
    buffer_load_dword v14, off, s[52:55], 0 sc1
Lpi2:
    s_waitcnt lgkmcnt(10)
    v_mfma_f32_32x32x16_bf16 v[32:47], v[96:99], v[224:227], v[32:47]
    ds_read_b128 v[236:239], v83 offset:32768
    ds_read_b64_tr_b16 v[96:97], v92 offset:55296
    ds_read_b64_tr_b16 v[98:99], v92 offset:55808
    v_mfma_f32_32x32x16_bf16 v[48:63], v[100:103], v[224:227], v[48:63]
    ds_read_b64_tr_b16 v[100:101], v92 offset:63488
    ds_read_b64_tr_b16 v[102:103], v92 offset:64000
    s_add_u32 s12, s71, 2
    s_and_b32 s12, s12, 7
    s_mul_i32 s12, s12, 196608
    s_add_u32 s12, s12, s77
    s_add_u32 m0, s79, 114688
    s_add_u32 s12, s12, 2048
    buffer_load_dwordx4 v11, s[36:39], s12 offen lds
    s_waitcnt lgkmcnt(10)
    v_mfma_f32_32x32x16_bf16 v[32:47], v[104:107], v[228:231], v[32:47]
    v_mfma_f32_32x32x16_bf16 v[48:63], v[108:111], v[228:231], v[48:63]
    s_add_u32 s12, s71, 3
    s_and_b32 s12, s12, 7
    s_mul_i32 s12, s12, 196608
    s_add_u32 s12, s12, s77
    s_add_u32 m0, s79, 122880
    s_add_u32 s12, s12, 2048
    buffer_load_dwordx4 v11, s[36:39], s12 offen lds
    s_waitcnt lgkmcnt(0)
    s_waitcnt vmcnt(4)
    s_barrier
    ds_read_b128 v[240:243], v84 offset:0
    ds_read_b64_tr_b16 v[104:105], v93 offset:16384
    ds_read_b64_tr_b16 v[106:107], v93 offset:16896
    ds_read_b64_tr_b16 v[108:109], v93 offset:24576
    ds_read_b64_tr_b16 v[110:111], v93 offset:25088
    v_mfma_f32_32x32x16_bf16 v[32:47], v[112:115], v[232:235], v[32:47]
    ds_read_b128 v[244:247], v85 offset:0
    ds_read_b64_tr_b16 v[112:113], v93 offset:18432
    ds_read_b64_tr_b16 v[114:115], v93 offset:18944
    v_mfma_f32_32x32x16_bf16 v[48:63], v[116:119], v[232:235], v[48:63]
    ds_read_b64_tr_b16 v[116:117], v93 offset:26624
    ds_read_b64_tr_b16 v[118:119], v93 offset:27136
    s_add_u32 s12, s71, 4
    s_and_b32 s12, s12, 7
    s_mul_i32 s12, s12, 196608
    s_add_u32 s12, s12, s77
    s_add_u32 m0, s79, 131072
    s_add_u32 s12, s12, 2048
    buffer_load_dwordx4 v11, s[36:39], s12 offen lds
    v_mfma_f32_32x32x16_bf16 v[32:47], v[96:99], v[236:239], v[32:47]
    ds_read_b128 v[248:251], v86 offset:0
    ds_read_b64_tr_b16 v[96:97], v93 offset:20480
    ds_read_b64_tr_b16 v[98:99], v93 offset:20992
    v_mfma_f32_32x32x16_bf16 v[48:63], v[100:103], v[236:239], v[48:63]
    ds_read_b64_tr_b16 v[100:101], v93 offset:28672
    ds_read_b64_tr_b16 v[102:103], v93 offset:29184
    s_add_u32 s12, s71, 5
    s_and_b32 s12, s12, 7
    s_mul_i32 s12, s12, 196608
    s_add_u32 s12, s12, s77
    s_add_u32 m0, s79, 139264
    s_add_u32 s12, s12, 2048
    buffer_load_dwordx4 v11, s[36:39], s12 offen lds
    s_waitcnt lgkmcnt(10)
    v_mfma_f32_32x32x16_bf16 v[32:47], v[104:107], v[240:243], v[32:47]
    ds_read_b128 v[252:255], v87 offset:0
    ds_read_b64_tr_b16 v[104:105], v93 offset:22528
    ds_read_b64_tr_b16 v[106:107], v93 offset:23040
    v_mfma_f32_32x32x16_bf16 v[48:63], v[108:111], v[240:243], v[48:63]
    ds_read_b64_tr_b16 v[108:109], v93 offset:30720
    ds_read_b64_tr_b16 v[110:111], v93 offset:31232
    s_add_u32 s12, s71, 6
    s_and_b32 s12, s12, 7
    s_mul_i32 s12, s12, 196608
    s_add_u32 s12, s12, s77
    s_add_u32 m0, s79, 147456
    s_add_u32 s12, s12, 2048
    buffer_load_dwordx4 v11, s[36:39], s12 offen lds
    s_waitcnt lgkmcnt(10)
    v_mfma_f32_32x32x16_bf16 v[32:47], v[112:115], v[244:247], v[32:47]
    v_mfma_f32_32x32x16_bf16 v[48:63], v[116:119], v[244:247], v[48:63]
    s_add_u32 s12, s71, 7
    s_and_b32 s12, s12, 7
    s_mul_i32 s12, s12, 196608
    s_add_u32 s12, s12, s77
    s_add_u32 m0, s79, 155648
    s_add_u32 s12, s12, 2048
    buffer_load_dwordx4 v11, s[36:39], s12 offen lds
    s_waitcnt lgkmcnt(0)
    s_waitcnt vmcnt(4)
    s_barrier
    ds_read_b64_tr_b16 v[112:113], v93 offset:32768
    ds_read_b64_tr_b16 v[114:115], v93 offset:33280
    ds_read_b64_tr_b16 v[116:117], v93 offset:34816
    ds_read_b64_tr_b16 v[118:119], v93 offset:35328
    v_mfma_f32_32x32x16_bf16 v[32:47], v[96:99], v[248:251], v[32:47]
    ds_read_b64_tr_b16 v[96:97], v93 offset:36864
    ds_read_b64_tr_b16 v[98:99], v93 offset:37376
    v_mfma_f32_32x32x16_bf16 v[48:63], v[100:103], v[248:251], v[48:63]
    ds_read_b64_tr_b16 v[100:101], v93 offset:38912
    ds_read_b64_tr_b16 v[102:103], v93 offset:39424
    v_mfma_f32_32x32x16_bf16 v[32:47], v[104:107], v[252:255], v[32:47]
    ds_read_b64_tr_b16 v[104:105], v93 offset:40960
    ds_read_b64_tr_b16 v[106:107], v93 offset:41472
    v_mfma_f32_32x32x16_bf16 v[48:63], v[108:111], v[252:255], v[48:63]
    ds_read_b64_tr_b16 v[108:109], v93 offset:43008
    ds_read_b64_tr_b16 v[110:111], v93 offset:43520
    s_waitcnt lgkmcnt(10)
    v_mfma_f32_32x32x16_bf16 v[16:31], v[128:131], v[112:115], 0
    ds_read_b64_tr_b16 v[112:113], v93 offset:45056
    ds_read_b64_tr_b16 v[114:115], v93 offset:45568
    s_waitcnt lgkmcnt(10)
    v_mfma_f32_32x32x16_bf16 v[16:31], v[132:135], v[116:119], v[16:31]
    ds_read_b64_tr_b16 v[116:117], v93 offset:47104
    ds_read_b64_tr_b16 v[118:119], v93 offset:47616
    v_cvt_pk_bf16_f32 v80, v32, v33
    v_cvt_pk_bf16_f32 v81, v34, v35
    v_cvt_pk_bf16_f32 v82, v36, v37
    v_cvt_pk_bf16_f32 v83, v38, v39
    v_cvt_pk_bf16_f32 v84, v40, v41
    v_cvt_pk_bf16_f32 v85, v42, v43
    v_cvt_pk_bf16_f32 v86, v44, v45
    s_waitcnt lgkmcnt(10)
    v_mfma_f32_32x32x16_bf16 v[16:31], v[136:139], v[96:99], v[16:31]
    ds_read_b64_tr_b16 v[96:97], v93 offset:49152
    ds_read_b64_tr_b16 v[98:99], v93 offset:49664
    v_cvt_pk_bf16_f32 v87, v46, v47
    s_lshr_b32 s74, s101, 1
    s_add_u32 s72, s74, 0x400000
    s_add_u32 s73, s72, 0x10000
    buffer_store_dwordx4 v[80:83], v2, s[40:43], s72 offen sc1
    buffer_store_dwordx4 v[84:87], v2, s[40:43], s73 offen sc1
    v_cvt_pk_bf16_f32 v64, v48, v49
    v_cvt_pk_bf16_f32 v65, v50, v51
    v_cvt_pk_bf16_f32 v66, v52, v53
    v_cvt_pk_bf16_f32 v67, v54, v55
    s_waitcnt lgkmcnt(10)
    v_mfma_f32_32x32x16_bf16 v[16:31], v[140:143], v[100:103], v[16:31]
    ds_read_b64_tr_b16 v[100:101], v93 offset:51200
    ds_read_b64_tr_b16 v[102:103], v93 offset:51712
    v_cvt_pk_bf16_f32 v68, v56, v57
    v_cvt_pk_bf16_f32 v69, v58, v59
    v_cvt_pk_bf16_f32 v70, v60, v61
    v_cvt_pk_bf16_f32 v71, v62, v63
    v_mfma_f32_32x32x16_bf16 v[32:47], v[120:123], v[64:67], 0
    s_nop 0
    v_mfma_f32_32x32x16_bf16 v[48:63], v[124:127], v[68:71], 0
    s_waitcnt lgkmcnt(10)
    v_mfma_f32_32x32x16_bf16 v[16:31], v[144:147], v[104:107], v[16:31]
    ds_read_b64_tr_b16 v[104:105], v93 offset:53248
    ds_read_b64_tr_b16 v[106:107], v93 offset:53760
    s_waitcnt lgkmcnt(10)
    v_mfma_f32_32x32x16_bf16 v[16:31], v[148:151], v[108:111], v[16:31]
    ds_read_b64_tr_b16 v[108:109], v93 offset:55296
    ds_read_b64_tr_b16 v[110:111], v93 offset:55808
    s_waitcnt lgkmcnt(10)
    v_mfma_f32_32x32x16_bf16 v[16:31], v[152:155], v[112:115], v[16:31]
    ds_read_b64_tr_b16 v[112:113], v93 offset:57344
    ds_read_b64_tr_b16 v[114:115], v93 offset:57856
    v_max3_f32 v64, v32, v33, v34
    v_max3_f32 v80, v48, v49, v50
    v_max3_f32 v66, v40, v41, v42
    v_max3_f32 v82, v56, v57, v58
    v_max3_f32 v65, v35, v36, v37
    v_max3_f32 v81, v51, v52, v53
    s_waitcnt lgkmcnt(10)
    v_mfma_f32_32x32x16_bf16 v[16:31], v[156:159], v[116:119], v[16:31]
    ds_read_b64_tr_b16 v[116:117], v93 offset:59392
    ds_read_b64_tr_b16 v[118:119], v93 offset:59904
    v_max3_f32 v67, v43, v44, v45
    v_max3_f32 v83, v59, v60, v61
    v_max3_f32 v64, v38, v39, v64
    v_max3_f32 v80, v54, v55, v80
    v_max3_f32 v66, v46, v47, v66
    s_waitcnt lgkmcnt(10)
    v_mfma_f32_32x32x16_bf16 v[16:31], v[160:163], v[96:99], v[16:31]
    ds_read_b64_tr_b16 v[96:97], v93 offset:61440
    ds_read_b64_tr_b16 v[98:99], v93 offset:61952
    v_max3_f32 v82, v62, v63, v82
    v_max_f32 v64, v64, v65
    v_max_f32 v80, v80, v81
    v_max_f32 v66, v66, v67
    v_max_f32 v82, v82, v83
    s_nop 0
    v_permlane32_swap_b32 v64, v66
    s_waitcnt lgkmcnt(10)
    v_mfma_f32_32x32x16_bf16 v[16:31], v[164:167], v[100:103], v[16:31]
    ds_read_b64_tr_b16 v[100:101], v93 offset:63488
    ds_read_b64_tr_b16 v[102:103], v93 offset:64000
    v_permlane32_swap_b32 v80, v82
    v_max_f32 v64, v64, v66
    v_max_f32 v80, v80, v82
    v_mul_f32 v64, s82, v64
    v_mul_f32 v80, s82, v80
    s_waitcnt vmcnt(2)
    s_cmp_lg_u32 s68, 0
    s_cbranch_scc1 Lpc3
    s_waitcnt vmcnt(8)
    s_mov_b32 s91, 0
Lsp4:
    v_readfirstlane_b32 s75, v14
    s_nop 0
    s_cmp_ge_u32 s75, 1
    s_cbranch_scc1 Lsd5
    buffer_load_dword v14, off, s[52:55], 0 sc1
    s_add_u32 s91, s91, 1
    s_cmp_lt_u32 s91, 400000
    s_waitcnt vmcnt(0)
    s_cbranch_scc1 Lsp4
Lsd5:
Lpc3:
    s_barrier
    s_waitcnt lgkmcnt(10)
    v_mfma_f32_32x32x16_bf16 v[16:31], v[168:171], v[104:107], v[16:31]
    ds_read_b64_tr_b16 v[104:105], v94 offset:0
    ds_read_b64_tr_b16 v[106:107], v94 offset:512
    v_mov_b32 v66, v64
    v_mov_b32 v82, v80
    s_nop 0
    v_permlane32_swap_b32 v64, v66
    v_permlane32_swap_b32 v80, v82
    v_mov_b32 v65, v64
    s_waitcnt lgkmcnt(10)
    v_mfma_f32_32x32x16_bf16 v[16:31], v[172:175], v[108:111], v[16:31]
    ds_read_b64_tr_b16 v[108:109], v94 offset:2048
    ds_read_b64_tr_b16 v[110:111], v94 offset:2560
    v_mov_b32 v81, v80
    v_mov_b32 v67, v66
    v_mov_b32 v83, v82
    v_pk_fma_f32 v[32:33], v[32:33], s[80:81], v[64:65]
    v_pk_fma_f32 v[48:49], v[48:49], s[80:81], v[80:81]
    v_pk_fma_f32 v[34:35], v[34:35], s[80:81], v[64:65]
    s_waitcnt lgkmcnt(10)
    v_mfma_f32_32x32x16_bf16 v[16:31], v[176:179], v[112:115], v[16:31]
    ds_read_b64_tr_b16 v[112:113], v94 offset:4096
    ds_read_b64_tr_b16 v[114:115], v94 offset:4608
    v_pk_fma_f32 v[50:51], v[50:51], s[80:81], v[80:81]
    v_pk_fma_f32 v[36:37], v[36:37], s[80:81], v[64:65]
    v_pk_fma_f32 v[52:53], v[52:53], s[80:81], v[80:81]
    v_pk_fma_f32 v[38:39], v[38:39], s[80:81], v[64:65]
    v_pk_fma_f32 v[54:55], v[54:55], s[80:81], v[80:81]
    s_waitcnt lgkmcnt(10)
    v_mfma_f32_32x32x16_bf16 v[16:31], v[180:183], v[116:119], v[16:31]
    ds_read_b64_tr_b16 v[116:117], v94 offset:6144
    ds_read_b64_tr_b16 v[118:119], v94 offset:6656
    v_pk_fma_f32 v[40:41], v[40:41], s[80:81], v[66:67]
    v_pk_fma_f32 v[56:57], v[56:57], s[80:81], v[82:83]
    v_pk_fma_f32 v[42:43], v[42:43], s[80:81], v[66:67]
    v_pk_fma_f32 v[58:59], v[58:59], s[80:81], v[82:83]
    v_pk_fma_f32 v[44:45], v[44:45], s[80:81], v[66:67]
    v_pk_fma_f32 v[60:61], v[60:61], s[80:81], v[82:83]
    s_waitcnt lgkmcnt(10)
    v_mfma_f32_32x32x16_bf16 v[16:31], v[184:187], v[96:99], v[16:31]
    ds_read_b64_tr_b16 v[96:97], v94 offset:8192
    ds_read_b64_tr_b16 v[98:99], v94 offset:8704
    v_pk_fma_f32 v[46:47], v[46:47], s[80:81], v[66:67]
    v_pk_fma_f32 v[62:63], v[62:63], s[80:81], v[82:83]
    v_exp_f32 v32, v32
    v_exp_f32 v48, v48
    v_exp_f32 v33, v33
    s_waitcnt lgkmcnt(10)
    v_mfma_f32_32x32x16_bf16 v[16:31], v[188:191], v[100:103], v[16:31]
    ds_read_b64_tr_b16 v[100:101], v94 offset:10240
    ds_read_b64_tr_b16 v[102:103], v94 offset:10752
    v_exp_f32 v49, v49
    v_exp_f32 v34, v34
    v_exp_f32 v50, v50
    v_exp_f32 v35, v35
    v_exp_f32 v51, v51
    s_waitcnt vmcnt(0)
    s_barrier
    s_cmp_lg_u32 s68, 1
    s_cbranch_scc1 Llf6
    v_mov_b32 v9, s6
    s_mov_b64 exec, 1
    buffer_store_dword v9, off, s[40:43], s7
    s_mov_b64 exec, -1
Llf6:
    s_waitcnt lgkmcnt(10)
    v_mfma_f32_32x32x16_bf16 v[16:31], v[192:195], v[104:107], v[16:31]
    ds_read_b64_tr_b16 v[104:105], v94 offset:12288
    ds_read_b64_tr_b16 v[106:107], v94 offset:12800
    v_exp_f32 v36, v36
    v_exp_f32 v52, v52
    v_exp_f32 v37, v37
    v_exp_f32 v53, v53
    v_exp_f32 v38, v38
    v_exp_f32 v54, v54
    s_waitcnt lgkmcnt(10)
    v_mfma_f32_32x32x16_bf16 v[16:31], v[196:199], v[108:111], v[16:31]
    ds_read_b64_tr_b16 v[108:109], v94 offset:14336
    ds_read_b64_tr_b16 v[110:111], v94 offset:14848
    v_exp_f32 v39, v39
    v_exp_f32 v55, v55
    v_exp_f32 v40, v40
    v_exp_f32 v56, v56
    v_exp_f32 v41, v41
    s_waitcnt lgkmcnt(10)
    v_mfma_f32_32x32x16_bf16 v[16:31], v[200:203], v[112:115], v[16:31]
    ds_read_b64_tr_b16 v[112:113], v94 offset:16384
    ds_read_b64_tr_b16 v[114:115], v94 offset:16896
    v_exp_f32 v57, v57
    v_exp_f32 v42, v42
    v_exp_f32 v58, v58
    v_exp_f32 v43, v43
    v_exp_f32 v59, v59
    s_waitcnt lgkmcnt(10)
    v_mfma_f32_32x32x16_bf16 v[16:31], v[204:207], v[116:119], v[16:31]
    ds_read_b64_tr_b16 v[116:117], v94 offset:18432
    ds_read_b64_tr_b16 v[118:119], v94 offset:18944
    v_exp_f32 v44, v44
    v_exp_f32 v60, v60
    v_exp_f32 v45, v45
    v_exp_f32 v61, v61
    v_exp_f32 v46, v46
    v_exp_f32 v62, v62
    s_waitcnt lgkmcnt(10)
    v_mfma_f32_32x32x16_bf16 v[16:31], v[208:211], v[96:99], v[16:31]
    ds_read_b64_tr_b16 v[96:97], v94 offset:20480
    ds_read_b64_tr_b16 v[98:99], v94 offset:20992
    v_exp_f32 v47, v47
    v_exp_f32 v63, v63
    v_pk_add_f32 v[64:65], v[32:33], v[34:35]
    v_pk_add_f32 v[80:81], v[48:49], v[50:51]
    v_pk_add_f32 v[66:67], v[36:37], v[38:39]
    s_waitcnt lgkmcnt(10)
    v_mfma_f32_32x32x16_bf16 v[16:31], v[212:215], v[100:103], v[16:31]
    ds_read_b64_tr_b16 v[100:101], v94 offset:22528
    ds_read_b64_tr_b16 v[102:103], v94 offset:23040
    v_pk_add_f32 v[82:83], v[52:53], v[54:55]
    v_pk_add_f32 v[68:69], v[40:41], v[42:43]
    v_pk_add_f32 v[84:85], v[56:57], v[58:59]
    v_pk_add_f32 v[70:71], v[44:45], v[46:47]
    v_pk_add_f32 v[86:87], v[60:61], v[62:63]
    v_pk_add_f32 v[64:65], v[64:65], v[66:67]
    s_waitcnt lgkmcnt(10)
    v_mfma_f32_32x32x16_bf16 v[16:31], v[216:219], v[104:107], v[16:31]
    ds_read_b64_tr_b16 v[104:105], v94 offset:24576
    ds_read_b64_tr_b16 v[106:107], v94 offset:25088
    v_pk_add_f32 v[80:81], v[80:81], v[82:83]
    v_pk_add_f32 v[68:69], v[68:69], v[70:71]
    v_pk_add_f32 v[84:85], v[84:85], v[86:87]
    v_add_f32 v64, v64, v65
    v_add_f32 v80, v80, v81
    s_waitcnt lgkmcnt(10)
    v_mfma_f32_32x32x16_bf16 v[16:31], v[220:223], v[108:111], v[16:31]
    ds_read_b64_tr_b16 v[108:109], v94 offset:26624
    ds_read_b64_tr_b16 v[110:111], v94 offset:27136
    v_add_f32 v66, v68, v69
    v_add_f32 v82, v84, v85
    s_nop 0
    v_permlane32_swap_b32 v64, v66
    v_permlane32_swap_b32 v80, v82
    v_add_f32 v64, v64, v66
    s_waitcnt lgkmcnt(10)
    v_mfma_f32_32x32x16_bf16 v[16:31], v[224:227], v[112:115], v[16:31]
    ds_read_b64_tr_b16 v[112:113], v94 offset:28672
    ds_read_b64_tr_b16 v[114:115], v94 offset:29184
    v_add_f32 v80, v80, v82
    v_rcp_f32 v64, v64
    v_rcp_f32 v80, v80
    v_mov_b32 v66, v64
    s_nop 0
    v_mov_b32 v82, v80
    v_permlane32_swap_b32 v64, v66
    s_waitcnt lgkmcnt(10)
    v_mfma_f32_32x32x16_bf16 v[16:31], v[228:231], v[116:119], v[16:31]
    ds_read_b64_tr_b16 v[116:117], v94 offset:30720
    ds_read_b64_tr_b16 v[118:119], v94 offset:31232
    v_permlane32_swap_b32 v80, v82
    v_mov_b32 v65, v64
    v_mov_b32 v81, v80
    v_mov_b32 v67, v66
    v_mov_b32 v83, v82
    s_waitcnt lgkmcnt(10)
    v_mfma_f32_32x32x16_bf16 v[16:31], v[232:235], v[96:99], v[16:31]
    v_pk_mul_f32 v[32:33], v[32:33], v[64:65]
    v_pk_mul_f32 v[48:49], v[48:49], v[80:81]
    v_pk_mul_f32 v[34:35], v[34:35], v[64:65]
    v_pk_mul_f32 v[50:51], v[50:51], v[80:81]
    v_pk_mul_f32 v[36:37], v[36:37], v[64:65]
    v_pk_mul_f32 v[52:53], v[52:53], v[80:81]
    s_waitcnt lgkmcnt(0)
    s_barrier
    v_mfma_f32_32x32x16_bf16 v[16:31], v[236:239], v[100:103], v[16:31]
    v_pk_mul_f32 v[38:39], v[38:39], v[64:65]
    v_pk_mul_f32 v[54:55], v[54:55], v[80:81]
    v_pk_mul_f32 v[40:41], v[40:41], v[66:67]
    v_pk_mul_f32 v[56:57], v[56:57], v[82:83]
    v_pk_mul_f32 v[42:43], v[42:43], v[66:67]
    v_mfma_f32_32x32x16_bf16 v[16:31], v[240:243], v[104:107], v[16:31]
    v_pk_mul_f32 v[58:59], v[58:59], v[82:83]
    v_pk_mul_f32 v[44:45], v[44:45], v[66:67]
    v_pk_mul_f32 v[60:61], v[60:61], v[82:83]
    v_pk_mul_f32 v[46:47], v[46:47], v[66:67]
    v_pk_mul_f32 v[62:63], v[62:63], v[82:83]
    v_and_b32 v9, 31, v1
    v_lshlrev_b32 v9, 2, v9
    buffer_load_dword v14, v9, s[40:43], s9 offen sc1
    v_mfma_f32_32x32x16_bf16 v[16:31], v[244:247], v[108:111], v[16:31]
    v_cvt_pk_bf16_f32 v128, v32, v33
    v_cvt_pk_bf16_f32 v136, v48, v49
    v_cvt_pk_bf16_f32 v129, v34, v35
    v_cvt_pk_bf16_f32 v137, v50, v51
    v_cvt_pk_bf16_f32 v130, v36, v37
    v_cvt_pk_bf16_f32 v138, v52, v53
    v_mfma_f32_32x32x16_bf16 v[16:31], v[248:251], v[112:115], v[16:31]
    v_cvt_pk_bf16_f32 v131, v38, v39
    v_cvt_pk_bf16_f32 v139, v54, v55
    v_cvt_pk_bf16_f32 v132, v40, v41
    v_cvt_pk_bf16_f32 v140, v56, v57
    v_cvt_pk_bf16_f32 v133, v42, v43
    v_mfma_f32_32x32x16_bf16 v[16:31], v[252:255], v[116:119], v[16:31]
    v_cvt_pk_bf16_f32 v141, v58, v59
    v_cvt_pk_bf16_f32 v134, v44, v45
    v_cvt_pk_bf16_f32 v142, v60, v61
    v_cvt_pk_bf16_f32 v135, v46, v47
    v_cvt_pk_bf16_f32 v143, v62, v63
    v_mfma_f32_32x32x16_bf16 v[32:47], v[128:131], v[72:75], 0
    v_mfma_f32_32x32x16_bf16 v[48:63], v[136:139], v[72:75], 0
    v_mfma_f32_32x32x16_bf16 v[32:47], v[132:135], v[76:79], v[32:47]
    v_mfma_f32_32x32x16_bf16 v[48:63], v[140:143], v[76:79], v[48:63]
    s_waitcnt vmcnt(0)
    s_mov_b32 s91, 0
Lsp7:
    v_cmp_ne_u32 vcc, s6, v14
    s_nop 0
    s_cbranch_vccz Lsd8
    s_add_u32 s91, s91, 1
    s_cmp_lt_u32 s91, 24
    s_cbranch_scc1 Lsn9
    s_lshl_b32 s73, s69, 8
    s_add_u32 s73, s73, 0xc10000
    s_cmp_lg_u32 s91, 24
    s_cbranch_scc1 Lsr10
    s_cmp_lg_u32 s68, 0
    s_cbranch_scc1 Lsr10
    v_mov_b32 v14, 1
    s_mov_b64 exec, 1
    buffer_atomic_add v14, off, s[40:43], s73 sc1
    s_mov_b64 exec, -1
Lsr10:
    s_sleep 16
    buffer_load_dword v14, off, s[40:43], s73 sc1
    s_waitcnt vmcnt(0)
    v_readfirstlane_b32 s75, v14
    s_nop 0
    s_cmp_ge_u32 s75, 32
    s_cselect_b32 s6, 0, s6
    s_cbranch_scc1 Lsd8
Lsn9:
    buffer_load_dword v14, v9, s[40:43], s9 offen sc1
    s_cmp_lt_u32 s91, 400000
    s_waitcnt vmcnt(0)
    s_cbranch_scc1 Lsp7
Lsd8:
    s_lshl_b32 s76, s88, 17
    s_lshl_b32 s72, s68, 11
    s_add_u32 s76, s76, s72
    s_lshl_b32 s72, s88, 16
    s_lshl_b32 s73, s90, 10
    s_add_u32 s72, s72, s73
    s_add_u32 s72, s72, 0x400000
    s_xor_b32 s73, s72, 1024
    buffer_load_dwordx4 v[120:123], v2, s[40:43], s72 offen sc1
    buffer_load_dwordx4 v[124:127], v2, s[40:43], s73 offen sc1
    s_lshl_b32 s72, s88, 17
    buffer_load_dwordx4 v[184:187], v2, s[40:43], s72 offen sc1
    s_add_u32 m0, s85, 0
    s_add_u32 s72, s76, 0
    buffer_load_dwordx4 v2, s[40:43], s72 offen sc1 lds
    buffer_load_dwordx4 v2, s[40:43], s72 offen offset:1024 sc1 lds
    s_add_u32 m0, s85, 8192
    s_add_u32 s72, s76, 16384
    buffer_load_dwordx4 v2, s[40:43], s72 offen sc1 lds
    buffer_load_dwordx4 v2, s[40:43], s72 offen offset:1024 sc1 lds
    v_mov_b32 v180, 0x3f803f80
    v_mov_b32 v181, 0x3f803f80
    v_mov_b64 v[160:161], v[180:181]
    v_mov_b64 v[162:163], v[180:181]
    v_mov_b64 v[164:165], v[180:181]
    v_mov_b64 v[166:167], v[180:181]
    v_mov_b64 v[168:169], v[180:181]
    v_mov_b64 v[170:171], v[180:181]
    v_mov_b64 v[172:173], v[180:181]
    v_mov_b64 v[174:175], v[180:181]
    s_mov_b64 exec, s[0:1]
    v_cvt_pk_bf16_f32 v160, v16, v17
    v_cvt_pk_bf16_f32 v161, v18, v19
    v_cvt_pk_bf16_f32 v162, v20, v21
    v_cvt_pk_bf16_f32 v163, v22, v23
    v_cvt_pk_bf16_f32 v164, v24, v25
    v_cvt_pk_bf16_f32 v165, v26, v27
    v_cvt_pk_bf16_f32 v166, v28, v29
    v_cvt_pk_bf16_f32 v167, v30, v31
    s_not_b64 exec, exec
    v_cvt_pk_bf16_f32 v168, v16, v17
    v_cvt_pk_bf16_f32 v169, v18, v19
    v_cvt_pk_bf16_f32 v170, v20, v21
    v_cvt_pk_bf16_f32 v171, v22, v23
    v_cvt_pk_bf16_f32 v172, v24, v25
    v_cvt_pk_bf16_f32 v173, v26, v27
    v_cvt_pk_bf16_f32 v174, v28, v29
    v_cvt_pk_bf16_f32 v175, v30, v31
    s_mov_b64 exec, -1
    v_cvt_pk_bf16_f32 v128, v32, v33
    v_cvt_pk_bf16_f32 v129, v34, v35
    v_cvt_pk_bf16_f32 v130, v36, v37
    v_cvt_pk_bf16_f32 v131, v38, v39
    v_cvt_pk_bf16_f32 v132, v40, v41
    v_cvt_pk_bf16_f32 v133, v42, v43
    v_cvt_pk_bf16_f32 v134, v44, v45
    v_cvt_pk_bf16_f32 v135, v46, v47
    v_cvt_pk_bf16_f32 v136, v48, v49
    v_cvt_pk_bf16_f32 v137, v50, v51
    v_cvt_pk_bf16_f32 v138, v52, v53
    v_cvt_pk_bf16_f32 v139, v54, v55
    v_cvt_pk_bf16_f32 v140, v56, v57
    v_cvt_pk_bf16_f32 v141, v58, v59
    v_cvt_pk_bf16_f32 v142, v60, v61
    v_cvt_pk_bf16_f32 v143, v62, v63
    v_mfma_f32_32x32x16_bf16 v[32:47], v[128:131], v[160:163], 0
    v_mfma_f32_32x32x16_bf16 v[48:63], v[136:139], v[168:171], 0
    v_mfma_f32_32x32x16_bf16 v[32:47], v[132:135], v[164:167], v[32:47]
    v_mfma_f32_32x32x16_bf16 v[48:63], v[140:143], v[172:175], v[48:63]
    v_and_b32 v10, 27, v1
    v_cmp_eq_u32 vcc, 16, v10
    v_mov_b32 v11, 0x3f803f80
    v_mov_b64 v[176:177], 0
    v_mov_b64 v[178:179], 0
    v_cndmask_b32 v104, 0, v11, vcc
    v_cndmask_b32 v105, 0, v11, vcc
    v_mfma_f32_32x32x16_bf16 v[64:79], v[176:179], v[176:179], 0
    v_mfma_f32_32x32x16_bf16 v[80:95], v[176:179], v[176:179], 0
    v_mov_b64 v[106:107], v[104:105]
    v_mov_b64 v[108:109], v[104:105]
    v_mov_b64 v[110:111], v[104:105]
    v_mov_b64 v[112:113], v[104:105]
    v_mov_b64 v[114:115], v[104:105]
    v_mov_b64 v[116:117], v[104:105]
    v_mov_b64 v[118:119], v[104:105]
    s_waitcnt vmcnt(4)
    v_mfma_f32_32x32x16_bf16 v[192:207], v[184:187], v[120:123], 0
    v_mfma_f32_32x32x16_bf16 v[208:223], v[184:187], v[124:127], 0
    ds_write_b128 v12, v[32:35] offset:0
    ds_write_b128 v12, v[36:39] offset:1024
    ds_write_b128 v12, v[40:43] offset:2048
    ds_write_b128 v12, v[44:47] offset:3072
    ds_write_b128 v13, v[48:51] offset:16384
    ds_write_b128 v13, v[52:55] offset:17408
    ds_write_b128 v13, v[56:59] offset:18432
    ds_write_b128 v13, v[60:63] offset:19456
    s_nop 3
    v_max3_f32 v10, v208, v209, v210
    v_max3_f32 v10, v211, v212, v10
    v_max3_f32 v10, v213, v214, v10
    v_max3_f32 v10, v215, v216, v10
    v_max3_f32 v10, v217, v218, v10
    v_max3_f32 v10, v219, v220, v10
    v_max3_f32 v10, v221, v222, v10
    v_max_f32 v10, v223, v10
    v_max3_f32 v9, v192, v193, v194
    v_max3_f32 v9, v195, v196, v9
    v_max3_f32 v9, v197, v198, v9
    v_max3_f32 v9, v199, v200, v9
    v_max3_f32 v9, v201, v202, v9
    v_max3_f32 v9, v203, v204, v9
    v_max3_f32 v9, v205, v206, v9
    v_max3_f32 v9, v207, v10, v9
    v_mov_b32 v10, v9
    s_nop 1
    v_permlane32_swap_b32 v9, v10
    v_max_f32 v9, v9, v10
    v_sub_f32 v16, 0, v9
    v_sub_f32 v17, 0, v9
    v_mov_b64 v[18:19], v[16:17]
    v_mov_b64 v[20:21], v[16:17]
    v_mov_b64 v[22:23], v[16:17]
    v_mov_b64 v[24:25], v[16:17]
    v_mov_b64 v[26:27], v[16:17]
    v_mov_b64 v[28:29], v[16:17]
    v_mov_b64 v[30:31], v[16:17]
    s_waitcnt lgkmcnt(0)
    s_waitcnt vmcnt(0)
    s_barrier
    s_branch L_P2
L_T1:
    s_waitcnt vmcnt(4)
    s_barrier
    ds_read_b128 v[128:131], v80 offset:0
    ds_read_b64_tr_b16 v[96:97], v92 offset:16384
    ds_read_b64_tr_b16 v[98:99], v92 offset:16896
    ds_read_b64_tr_b16 v[100:101], v92 offset:24576
    ds_read_b64_tr_b16 v[102:103], v92 offset:25088
    ds_read_b128 v[132:135], v81 offset:0
    ds_read_b64_tr_b16 v[104:105], v92 offset:18432
    ds_read_b64_tr_b16 v[106:107], v92 offset:18944
    ds_read_b64_tr_b16 v[108:109], v92 offset:26624
    ds_read_b64_tr_b16 v[110:111], v92 offset:27136
    ds_read_b128 v[136:139], v82 offset:0
    ds_read_b64_tr_b16 v[112:113], v92 offset:20480
    ds_read_b64_tr_b16 v[114:115], v92 offset:20992
    ds_read_b64_tr_b16 v[116:117], v92 offset:28672
    ds_read_b64_tr_b16 v[118:119], v92 offset:29184
    ds_read_b64_tr_b16 v[120:121], v78 offset:0
    ds_read_b64_tr_b16 v[122:123], v78 offset:256
    ds_read_b64_tr_b16 v[124:125], v78 offset:512
    ds_read_b64_tr_b16 v[126:127], v78 offset:768
    s_add_u32 s12, s71, 2
    s_and_b32 s12, s12, 7
    s_lshl_b32 s13, s12, 7
    s_add_u32 m0, s78, 65536
    s_add_u32 s13, s13, s76
    buffer_load_dwordx4 v9, s[28:31], s13 offen lds
    buffer_load_dwordx4 v10, s[28:31], s13 offen offset:1024 lds
    s_waitcnt lgkmcnt(14)
    v_mfma_f32_32x32x16_bf16 v[32:47], v[96:99], v[128:131], 0
    ds_read_b128 v[140:143], v83 offset:0
    ds_read_b64_tr_b16 v[96:97], v92 offset:22528
    ds_read_b64_tr_b16 v[98:99], v92 offset:23040
    v_mfma_f32_32x32x16_bf16 v[48:63], v[128:131], v[100:103], 0
    ds_read_b64_tr_b16 v[100:101], v92 offset:30720
    ds_read_b64_tr_b16 v[102:103], v92 offset:31232
    s_mul_i32 s12, s12, 196608
    s_add_u32 m0, s79, 81920
    s_add_u32 s12, s12, s77
    buffer_load_dwordx4 v11, s[32:35], s12 offen lds
    s_waitcnt lgkmcnt(14)
    v_mfma_f32_32x32x16_bf16 v[32:47], v[104:107], v[132:135], v[32:47]
    v_mfma_f32_32x32x16_bf16 v[48:63], v[132:135], v[108:111], v[48:63]
    s_add_u32 m0, s79, 89088
    s_nop 0
    buffer_load_dwordx4 v11, s[44:47], s12 offen offset:1024 lds
    s_waitcnt lgkmcnt(0)
    s_waitcnt vmcnt(4)
    s_barrier
    ds_read_b128 v[144:147], v80 offset:32768
    ds_read_b64_tr_b16 v[104:105], v92 offset:49152
    ds_read_b64_tr_b16 v[106:107], v92 offset:49664
    ds_read_b64_tr_b16 v[108:109], v92 offset:57344
    ds_read_b64_tr_b16 v[110:111], v92 offset:57856
    v_mfma_f32_32x32x16_bf16 v[32:47], v[112:115], v[136:139], v[32:47]
    ds_read_b128 v[148:151], v81 offset:32768
    ds_read_b64_tr_b16 v[112:113], v92 offset:51200
    ds_read_b64_tr_b16 v[114:115], v92 offset:51712
    v_mfma_f32_32x32x16_bf16 v[48:63], v[136:139], v[116:119], v[48:63]
    ds_read_b64_tr_b16 v[116:117], v92 offset:59392
    ds_read_b64_tr_b16 v[118:119], v92 offset:59904
    s_add_u32 s12, s71, 3
    s_and_b32 s12, s12, 7
    s_lshl_b32 s13, s12, 7
    s_add_u32 m0, s78, 98304
    s_add_u32 s13, s13, s76
    buffer_load_dwordx4 v9, s[28:31], s13 offen lds
    v_mfma_f32_32x32x16_bf16 v[32:47], v[96:99], v[140:143], v[32:47]
    ds_read_b128 v[152:155], v82 offset:32768
    ds_read_b64_tr_b16 v[96:97], v92 offset:53248
    ds_read_b64_tr_b16 v[98:99], v92 offset:53760
    v_mfma_f32_32x32x16_bf16 v[48:63], v[140:143], v[100:103], v[48:63]
    ds_read_b64_tr_b16 v[100:101], v92 offset:61440
    ds_read_b64_tr_b16 v[102:103], v92 offset:61952
    buffer_load_dwordx4 v10, s[28:31], s13 offen offset:1024 lds
    s_waitcnt lgkmcnt(10)
    v_mfma_f32_32x32x16_bf16 v[32:47], v[104:107], v[144:147], v[32:47]
    ds_read_b128 v[156:159], v83 offset:32768
    ds_read_b64_tr_b16 v[104:105], v92 offset:55296
    ds_read_b64_tr_b16 v[106:107], v92 offset:55808
    v_mfma_f32_32x32x16_bf16 v[48:63], v[144:147], v[108:111], v[48:63]
    ds_read_b64_tr_b16 v[108:109], v92 offset:63488
    ds_read_b64_tr_b16 v[110:111], v92 offset:64000
    s_mul_i32 s12, s12, 196608
    s_add_u32 m0, s79, 114688
    s_add_u32 s12, s12, s77
    buffer_load_dwordx4 v11, s[32:35], s12 offen lds
    s_waitcnt lgkmcnt(10)
    v_mfma_f32_32x32x16_bf16 v[32:47], v[112:115], v[148:151], v[32:47]
    v_mfma_f32_32x32x16_bf16 v[48:63], v[148:151], v[116:119], v[48:63]
    s_add_u32 m0, s79, 121856
    s_nop 0
    buffer_load_dwordx4 v11, s[44:47], s12 offen offset:1024 lds
    s_waitcnt lgkmcnt(0)
    s_waitcnt vmcnt(4)
    s_barrier
    ds_read_b128 v[160:163], v84 offset:0
    ds_read_b64_tr_b16 v[112:113], v93 offset:16384
    ds_read_b64_tr_b16 v[114:115], v93 offset:16896
    ds_read_b64_tr_b16 v[116:117], v93 offset:24576
    ds_read_b64_tr_b16 v[118:119], v93 offset:25088
    v_mfma_f32_32x32x16_bf16 v[32:47], v[96:99], v[152:155], v[32:47]
    ds_read_b128 v[164:167], v85 offset:0
    ds_read_b64_tr_b16 v[96:97], v93 offset:18432
    ds_read_b64_tr_b16 v[98:99], v93 offset:18944
    v_mfma_f32_32x32x16_bf16 v[48:63], v[152:155], v[100:103], v[48:63]
    ds_read_b64_tr_b16 v[100:101], v93 offset:26624
    ds_read_b64_tr_b16 v[102:103], v93 offset:27136
    s_add_u32 s12, s71, 4
    s_and_b32 s12, s12, 7
    s_lshl_b32 s13, s12, 7
    s_add_u32 m0, s78, 131072
    s_add_u32 s13, s13, s76
    buffer_load_dwordx4 v9, s[28:31], s13 offen lds
    v_mfma_f32_32x32x16_bf16 v[32:47], v[104:107], v[156:159], v[32:47]
    ds_read_b128 v[168:171], v86 offset:0
    ds_read_b64_tr_b16 v[104:105], v93 offset:20480
    ds_read_b64_tr_b16 v[106:107], v93 offset:20992
    v_mfma_f32_32x32x16_bf16 v[48:63], v[156:159], v[108:111], v[48:63]
    ds_read_b64_tr_b16 v[108:109], v93 offset:28672
    ds_read_b64_tr_b16 v[110:111], v93 offset:29184
    buffer_load_dwordx4 v10, s[28:31], s13 offen offset:1024 lds
    v_xor_b32 v120, v79, v120
    v_xor_b32 v121, v79, v121
    v_xor_b32 v122, v79, v122
    v_xor_b32 v123, v79, v123
    v_xor_b32 v124, v79, v124
    v_xor_b32 v125, v79, v125
    v_xor_b32 v126, v79, v126
    v_xor_b32 v127, v79, v127
    s_waitcnt lgkmcnt(10)
    v_mfma_f32_32x32x16_bf16 v[32:47], v[112:115], v[160:163], v[32:47]
    ds_read_b128 v[172:175], v87 offset:0
    ds_read_b64_tr_b16 v[112:113], v93 offset:22528
    ds_read_b64_tr_b16 v[114:115], v93 offset:23040
    v_mfma_f32_32x32x16_bf16 v[48:63], v[160:163], v[116:119], v[48:63]
    ds_read_b64_tr_b16 v[116:117], v93 offset:30720
    ds_read_b64_tr_b16 v[118:119], v93 offset:31232
    s_mul_i32 s12, s12, 196608
    s_add_u32 m0, s79, 147456
    s_add_u32 s12, s12, s77
    buffer_load_dwordx4 v11, s[32:35], s12 offen lds
    s_waitcnt lgkmcnt(10)
    v_mfma_f32_32x32x16_bf16 v[32:47], v[96:99], v[164:167], v[32:47]
    v_mfma_f32_32x32x16_bf16 v[48:63], v[164:167], v[100:103], v[48:63]
    s_add_u32 m0, s79, 154624
    s_nop 0
    buffer_load_dwordx4 v11, s[44:47], s12 offen offset:1024 lds
    s_waitcnt lgkmcnt(0)
    s_waitcnt vmcnt(4)
    s_barrier
    ds_read_b128 v[176:179], v84 offset:32768
    ds_read_b64_tr_b16 v[96:97], v93 offset:49152
    ds_read_b64_tr_b16 v[98:99], v93 offset:49664
    ds_read_b64_tr_b16 v[100:101], v93 offset:57344
    ds_read_b64_tr_b16 v[102:103], v93 offset:57856
    v_mfma_f32_32x32x16_bf16 v[32:47], v[104:107], v[168:171], v[32:47]
    ds_read_b128 v[180:183], v85 offset:32768
    ds_read_b64_tr_b16 v[104:105], v93 offset:51200
    ds_read_b64_tr_b16 v[106:107], v93 offset:51712
    v_mfma_f32_32x32x16_bf16 v[48:63], v[168:171], v[108:111], v[48:63]
    ds_read_b64_tr_b16 v[108:109], v93 offset:59392
    ds_read_b64_tr_b16 v[110:111], v93 offset:59904
    s_add_u32 s12, s71, 5
    s_and_b32 s12, s12, 7
    s_lshl_b32 s13, s12, 7
    s_add_u32 m0, s78, 0
    s_add_u32 s13, s13, s76
    buffer_load_dwordx4 v9, s[28:31], s13 offen lds
    v_mfma_f32_32x32x16_bf16 v[32:47], v[112:115], v[172:175], v[32:47]
    ds_read_b128 v[184:187], v86 offset:32768
    ds_read_b64_tr_b16 v[112:113], v93 offset:53248
    ds_read_b64_tr_b16 v[114:115], v93 offset:53760
    v_mfma_f32_32x32x16_bf16 v[48:63], v[172:175], v[116:119], v[48:63]
    ds_read_b64_tr_b16 v[116:117], v93 offset:61440
    ds_read_b64_tr_b16 v[118:119], v93 offset:61952
    buffer_load_dwordx4 v10, s[28:31], s13 offen offset:1024 lds
    s_waitcnt lgkmcnt(10)
    v_mfma_f32_32x32x16_bf16 v[32:47], v[96:99], v[176:179], v[32:47]
    ds_read_b128 v[188:191], v87 offset:32768
    ds_read_b64_tr_b16 v[96:97], v93 offset:55296
    ds_read_b64_tr_b16 v[98:99], v93 offset:55808
    v_mfma_f32_32x32x16_bf16 v[48:63], v[176:179], v[100:103], v[48:63]
    ds_read_b64_tr_b16 v[100:101], v93 offset:63488
    ds_read_b64_tr_b16 v[102:103], v93 offset:64000
    s_mul_i32 s12, s12, 196608
    s_add_u32 m0, s79, 16384
    s_add_u32 s12, s12, s77
    buffer_load_dwordx4 v11, s[32:35], s12 offen lds
    s_waitcnt lgkmcnt(10)
    v_mfma_f32_32x32x16_bf16 v[32:47], v[104:107], v[180:183], v[32:47]
    v_mfma_f32_32x32x16_bf16 v[48:63], v[180:183], v[108:111], v[48:63]
    s_add_u32 m0, s79, 23552
    s_nop 0
    buffer_load_dwordx4 v11, s[44:47], s12 offen offset:1024 lds
    s_waitcnt lgkmcnt(0)
    s_waitcnt vmcnt(4)
    s_barrier
    ds_read_b128 v[192:195], v88 offset:0
    ds_read_b64_tr_b16 v[104:105], v94 offset:16384
    ds_read_b64_tr_b16 v[106:107], v94 offset:16896
    ds_read_b64_tr_b16 v[108:109], v94 offset:24576
    ds_read_b64_tr_b16 v[110:111], v94 offset:25088
    v_mfma_f32_32x32x16_bf16 v[32:47], v[112:115], v[184:187], v[32:47]
    ds_read_b128 v[196:199], v89 offset:0
    ds_read_b64_tr_b16 v[112:113], v94 offset:18432
    ds_read_b64_tr_b16 v[114:115], v94 offset:18944
    v_mfma_f32_32x32x16_bf16 v[48:63], v[184:187], v[116:119], v[48:63]
    ds_read_b64_tr_b16 v[116:117], v94 offset:26624
    ds_read_b64_tr_b16 v[118:119], v94 offset:27136
    s_add_u32 s12, s71, 6
    s_and_b32 s12, s12, 7
    s_lshl_b32 s13, s12, 7
    s_add_u32 m0, s78, 32768
    s_add_u32 s13, s13, s76
    buffer_load_dwordx4 v9, s[28:31], s13 offen lds
    v_mfma_f32_32x32x16_bf16 v[32:47], v[96:99], v[188:191], v[32:47]
    ds_read_b128 v[200:203], v90 offset:0
    ds_read_b64_tr_b16 v[96:97], v94 offset:20480
    ds_read_b64_tr_b16 v[98:99], v94 offset:20992
    v_mfma_f32_32x32x16_bf16 v[48:63], v[188:191], v[100:103], v[48:63]
    ds_read_b64_tr_b16 v[100:101], v94 offset:28672
    ds_read_b64_tr_b16 v[102:103], v94 offset:29184
    buffer_load_dwordx4 v10, s[28:31], s13 offen offset:1024 lds
    s_waitcnt lgkmcnt(10)
    v_mfma_f32_32x32x16_bf16 v[32:47], v[104:107], v[192:195], v[32:47]
    ds_read_b128 v[204:207], v91 offset:0
    ds_read_b64_tr_b16 v[104:105], v94 offset:22528
    ds_read_b64_tr_b16 v[106:107], v94 offset:23040
    v_mfma_f32_32x32x16_bf16 v[48:63], v[192:195], v[108:111], v[48:63]
    ds_read_b64_tr_b16 v[108:109], v94 offset:30720
    ds_read_b64_tr_b16 v[110:111], v94 offset:31232
    s_mul_i32 s12, s12, 196608
    s_add_u32 m0, s79, 49152
    s_add_u32 s12, s12, s77
    buffer_load_dwordx4 v11, s[32:35], s12 offen lds
    s_waitcnt lgkmcnt(10)
    v_mfma_f32_32x32x16_bf16 v[32:47], v[112:115], v[196:199], v[32:47]
    v_mfma_f32_32x32x16_bf16 v[48:63], v[196:199], v[116:119], v[48:63]
    s_add_u32 m0, s79, 56320
    s_nop 0
    buffer_load_dwordx4 v11, s[44:47], s12 offen offset:1024 lds
    s_waitcnt lgkmcnt(0)
    s_waitcnt vmcnt(4)
    s_barrier
    ds_read_b128 v[208:211], v80 offset:0
    ds_read_b64_tr_b16 v[112:113], v92 offset:16384
    ds_read_b64_tr_b16 v[114:115], v92 offset:16896
    ds_read_b64_tr_b16 v[116:117], v92 offset:24576
    ds_read_b64_tr_b16 v[118:119], v92 offset:25088
    v_mfma_f32_32x32x16_bf16 v[32:47], v[96:99], v[200:203], v[32:47]
    ds_read_b128 v[212:215], v81 offset:0
    ds_read_b64_tr_b16 v[96:97], v92 offset:18432
    ds_read_b64_tr_b16 v[98:99], v92 offset:18944
    v_mfma_f32_32x32x16_bf16 v[48:63], v[200:203], v[100:103], v[48:63]
    ds_read_b64_tr_b16 v[100:101], v92 offset:26624
    ds_read_b64_tr_b16 v[102:103], v92 offset:27136
    s_add_u32 s12, s71, 7
    s_and_b32 s12, s12, 7
    s_lshl_b32 s13, s12, 7
    s_add_u32 m0, s78, 65536
    s_add_u32 s13, s13, s76
    buffer_load_dwordx4 v9, s[28:31], s13 offen lds
    v_mfma_f32_32x32x16_bf16 v[32:47], v[104:107], v[204:207], v[32:47]
    ds_read_b128 v[216:219], v82 offset:0
    ds_read_b64_tr_b16 v[104:105], v92 offset:20480
    ds_read_b64_tr_b16 v[106:107], v92 offset:20992
    v_mfma_f32_32x32x16_bf16 v[48:63], v[204:207], v[108:111], v[48:63]
    ds_read_b64_tr_b16 v[108:109], v92 offset:28672
    ds_read_b64_tr_b16 v[110:111], v92 offset:29184
    buffer_load_dwordx4 v10, s[28:31], s13 offen offset:1024 lds
    s_waitcnt lgkmcnt(10)
    v_mfma_f32_32x32x16_bf16 v[32:47], v[112:115], v[208:211], v[32:47]
    ds_read_b128 v[220:223], v83 offset:0
    ds_read_b64_tr_b16 v[112:113], v92 offset:22528
    ds_read_b64_tr_b16 v[114:115], v92 offset:23040
    v_mfma_f32_32x32x16_bf16 v[48:63], v[208:211], v[116:119], v[48:63]
    ds_read_b64_tr_b16 v[116:117], v92 offset:30720
    ds_read_b64_tr_b16 v[118:119], v92 offset:31232
    s_mul_i32 s12, s12, 196608
    s_add_u32 m0, s79, 81920
    s_add_u32 s12, s12, s77
    buffer_load_dwordx4 v11, s[32:35], s12 offen lds
    s_waitcnt lgkmcnt(10)
    v_mfma_f32_32x32x16_bf16 v[32:47], v[96:99], v[212:215], v[32:47]
    v_mfma_f32_32x32x16_bf16 v[48:63], v[212:215], v[100:103], v[48:63]
    s_add_u32 m0, s79, 89088
    s_nop 0
    buffer_load_dwordx4 v11, s[44:47], s12 offen offset:1024 lds
    s_waitcnt lgkmcnt(0)
    s_waitcnt vmcnt(4)
    s_barrier
    ds_read_b128 v[224:227], v80 offset:32768
    ds_read_b64_tr_b16 v[96:97], v92 offset:49152
    ds_read_b64_tr_b16 v[98:99], v92 offset:49664
    ds_read_b64_tr_b16 v[100:101], v92 offset:57344
    ds_read_b64_tr_b16 v[102:103], v92 offset:57856
    v_mfma_f32_32x32x16_bf16 v[32:47], v[104:107], v[216:219], v[32:47]
    ds_read_b128 v[228:231], v81 offset:32768
    ds_read_b64_tr_b16 v[104:105], v92 offset:51200
    ds_read_b64_tr_b16 v[106:107], v92 offset:51712
    v_mfma_f32_32x32x16_bf16 v[48:63], v[216:219], v[108:111], v[48:63]
    ds_read_b64_tr_b16 v[108:109], v92 offset:59392
    ds_read_b64_tr_b16 v[110:111], v92 offset:59904
    s_add_u32 s12, s71, 0
    s_and_b32 s12, s12, 7
    s_mul_i32 s12, s12, 196608
    s_add_u32 s12, s12, s77
    s_add_u32 m0, s79, 98304
    s_add_u32 s12, s12, -1024
    buffer_load_dwordx4 v11, s[36:39], s12 offen lds
    v_mfma_f32_32x32x16_bf16 v[32:47], v[112:115], v[220:223], v[32:47]
    ds_read_b128 v[232:235], v82 offset:32768
    ds_read_b64_tr_b16 v[112:113], v92 offset:53248
    ds_read_b64_tr_b16 v[114:115], v92 offset:53760
    v_mfma_f32_32x32x16_bf16 v[48:63], v[220:223], v[116:119], v[48:63]
    ds_read_b64_tr_b16 v[116:117], v92 offset:61440
    ds_read_b64_tr_b16 v[118:119], v92 offset:61952
    s_add_u32 s12, s71, 1
    s_and_b32 s12, s12, 7
    s_mul_i32 s12, s12, 196608
    s_add_u32 s12, s12, s77
    s_add_u32 m0, s79, 106496
    s_add_u32 s12, s12, -1024
    buffer_load_dwordx4 v11, s[36:39], s12 offen lds
    s_cmp_lg_u32 s68, 0
    s_cbranch_scc1 Lpi12
    buffer_load_dword v14, off, s[52:55], 0 sc1
Lpi12:
    s_waitcnt lgkmcnt(10)
    v_mfma_f32_32x32x16_bf16 v[32:47], v[96:99], v[224:227], v[32:47]
    ds_read_b128 v[236:239], v83 offset:32768
    ds_read_b64_tr_b16 v[96:97], v92 offset:55296
    ds_read_b64_tr_b16 v[98:99], v92 offset:55808
    v_mfma_f32_32x32x16_bf16 v[48:63], v[224:227], v[100:103], v[48:63]
    ds_read_b64_tr_b16 v[100:101], v92 offset:63488
    ds_read_b64_tr_b16 v[102:103], v92 offset:64000
    s_add_u32 s12, s71, 2
    s_and_b32 s12, s12, 7
    s_mul_i32 s12, s12, 196608
    s_add_u32 s12, s12, s77
    s_add_u32 m0, s79, 114688
    s_add_u32 s12, s12, -1024
    buffer_load_dwordx4 v11, s[36:39], s12 offen lds
    s_waitcnt lgkmcnt(10)
    v_mfma_f32_32x32x16_bf16 v[32:47], v[104:107], v[228:231], v[32:47]
    v_mfma_f32_32x32x16_bf16 v[48:63], v[228:231], v[108:111], v[48:63]
    s_add_u32 s12, s71, 3
    s_and_b32 s12, s12, 7
    s_mul_i32 s12, s12, 196608
    s_add_u32 s12, s12, s77
    s_add_u32 m0, s79, 122880
    s_add_u32 s12, s12, -1024
    buffer_load_dwordx4 v11, s[36:39], s12 offen lds
    s_waitcnt lgkmcnt(0)
    s_waitcnt vmcnt(4)
    s_barrier
    ds_read_b128 v[240:243], v84 offset:0
    ds_read_b64_tr_b16 v[104:105], v93 offset:16384
    ds_read_b64_tr_b16 v[106:107], v93 offset:16896
    ds_read_b64_tr_b16 v[108:109], v93 offset:24576
    ds_read_b64_tr_b16 v[110:111], v93 offset:25088
    v_mfma_f32_32x32x16_bf16 v[32:47], v[112:115], v[232:235], v[32:47]
    ds_read_b128 v[244:247], v85 offset:0
    ds_read_b64_tr_b16 v[112:113], v93 offset:18432
    ds_read_b64_tr_b16 v[114:115], v93 offset:18944
    v_mfma_f32_32x32x16_bf16 v[48:63], v[232:235], v[116:119], v[48:63]
    ds_read_b64_tr_b16 v[116:117], v93 offset:26624
    ds_read_b64_tr_b16 v[118:119], v93 offset:27136
    s_add_u32 s12, s71, 4
    s_and_b32 s12, s12, 7
    s_mul_i32 s12, s12, 196608
    s_add_u32 s12, s12, s77
    s_add_u32 m0, s79, 131072
    s_add_u32 s12, s12, -1024
    buffer_load_dwordx4 v11, s[36:39], s12 offen lds
    v_mfma_f32_32x32x16_bf16 v[32:47], v[96:99], v[236:239], v[32:47]
    ds_read_b128 v[248:251], v86 offset:0
    ds_read_b64_tr_b16 v[96:97], v93 offset:20480
    ds_read_b64_tr_b16 v[98:99], v93 offset:20992
    v_mfma_f32_32x32x16_bf16 v[48:63], v[236:239], v[100:103], v[48:63]
    ds_read_b64_tr_b16 v[100:101], v93 offset:28672
    ds_read_b64_tr_b16 v[102:103], v93 offset:29184
    s_add_u32 s12, s71, 5
    s_and_b32 s12, s12, 7
    s_mul_i32 s12, s12, 196608
    s_add_u32 s12, s12, s77
    s_add_u32 m0, s79, 139264
    s_add_u32 s12, s12, -1024
    buffer_load_dwordx4 v11, s[36:39], s12 offen lds
    s_waitcnt lgkmcnt(10)
    v_mfma_f32_32x32x16_bf16 v[32:47], v[104:107], v[240:243], v[32:47]
    ds_read_b128 v[252:255], v87 offset:0
    ds_read_b64_tr_b16 v[104:105], v93 offset:22528
    ds_read_b64_tr_b16 v[106:107], v93 offset:23040
    v_mfma_f32_32x32x16_bf16 v[48:63], v[240:243], v[108:111], v[48:63]
    ds_read_b64_tr_b16 v[108:109], v93 offset:30720
    ds_read_b64_tr_b16 v[110:111], v93 offset:31232
    s_add_u32 s12, s71, 6
    s_and_b32 s12, s12, 7
    s_mul_i32 s12, s12, 196608
    s_add_u32 s12, s12, s77
    s_add_u32 m0, s79, 147456
    s_add_u32 s12, s12, -1024
    buffer_load_dwordx4 v11, s[36:39], s12 offen lds
    s_lshl_b32 s72, s100, 10
    buffer_load_dwordx4 v[72:75], v2, s[28:31], s72 offen
    buffer_load_dwordx4 v[76:79], v2, s[28:31], s72 offen offset:1024
    buffer_load_dwordx4 v[88:91], v2, s[48:51], 0 offen
    s_waitcnt lgkmcnt(10)
    v_mfma_f32_32x32x16_bf16 v[32:47], v[112:115], v[244:247], v[32:47]
    v_mfma_f32_32x32x16_bf16 v[48:63], v[244:247], v[116:119], v[48:63]
    s_add_u32 s12, s71, 7
    s_and_b32 s12, s12, 7
    s_mul_i32 s12, s12, 196608
    s_add_u32 s12, s12, s77
    s_add_u32 m0, s79, 155648
    s_add_u32 s12, s12, -1024
    buffer_load_dwordx4 v11, s[36:39], s12 offen lds
    s_waitcnt lgkmcnt(0)
    s_waitcnt vmcnt(7)
    s_barrier
    ds_read_b64_tr_b16 v[112:113], v93 offset:32768
    ds_read_b64_tr_b16 v[114:115], v93 offset:33280
    ds_read_b64_tr_b16 v[116:117], v93 offset:34816
    ds_read_b64_tr_b16 v[118:119], v93 offset:35328
    v_mfma_f32_32x32x16_bf16 v[32:47], v[96:99], v[248:251], v[32:47]
    ds_read_b64_tr_b16 v[96:97], v93 offset:36864
    ds_read_b64_tr_b16 v[98:99], v93 offset:37376
    v_mfma_f32_32x32x16_bf16 v[48:63], v[248:251], v[100:103], v[48:63]
    ds_read_b64_tr_b16 v[100:101], v93 offset:38912
    ds_read_b64_tr_b16 v[102:103], v93 offset:39424
    v_mfma_f32_32x32x16_bf16 v[32:47], v[104:107], v[252:255], v[32:47]
    ds_read_b64_tr_b16 v[104:105], v93 offset:40960
    ds_read_b64_tr_b16 v[106:107], v93 offset:41472
    v_mfma_f32_32x32x16_bf16 v[48:63], v[252:255], v[108:111], v[48:63]
    ds_read_b64_tr_b16 v[108:109], v93 offset:43008
    ds_read_b64_tr_b16 v[110:111], v93 offset:43520
    s_waitcnt lgkmcnt(10)
    v_mfma_f32_32x32x16_bf16 v[16:31], v[112:115], v[128:131], 0
    ds_read_b64_tr_b16 v[112:113], v93 offset:45056
    ds_read_b64_tr_b16 v[114:115], v93 offset:45568
    s_waitcnt lgkmcnt(10)
    v_mfma_f32_32x32x16_bf16 v[16:31], v[116:119], v[132:135], v[16:31]
    ds_read_b64_tr_b16 v[116:117], v93 offset:47104
    ds_read_b64_tr_b16 v[118:119], v93 offset:47616
    s_add_u32 s74, s101, 0x20000
    v_mul_f32 v32, s84, v32
    v_mul_f32 v33, s84, v33
    v_mul_f32 v34, s84, v34
    v_mul_f32 v35, s84, v35
    v_mul_f32 v36, s84, v36
    v_mul_f32 v37, s84, v37
    v_mul_f32 v38, s84, v38
    v_mul_f32 v39, s84, v39
    v_mul_f32 v40, s84, v40
    s_waitcnt lgkmcnt(10)
    v_mfma_f32_32x32x16_bf16 v[16:31], v[96:99], v[136:139], v[16:31]
    ds_read_b64_tr_b16 v[96:97], v93 offset:49152
    ds_read_b64_tr_b16 v[98:99], v93 offset:49664
    v_mul_f32 v41, s84, v41
    v_mul_f32 v42, s84, v42
    v_mul_f32 v43, s84, v43
    v_mul_f32 v44, s84, v44
    v_mul_f32 v45, s84, v45
    v_mul_f32 v46, s84, v46
    v_mul_f32 v47, s84, v47
    v_cvt_pk_bf16_f32 v64, v48, v49
    v_cvt_pk_bf16_f32 v65, v50, v51
    s_waitcnt lgkmcnt(10)
    v_mfma_f32_32x32x16_bf16 v[16:31], v[100:103], v[140:143], v[16:31]
    ds_read_b64_tr_b16 v[100:101], v93 offset:51200
    ds_read_b64_tr_b16 v[102:103], v93 offset:51712
    v_cvt_pk_bf16_f32 v66, v52, v53
    v_cvt_pk_bf16_f32 v67, v54, v55
    v_cvt_pk_bf16_f32 v68, v56, v57
    v_cvt_pk_bf16_f32 v69, v58, v59
    v_cvt_pk_bf16_f32 v70, v60, v61
    v_cvt_pk_bf16_f32 v71, v62, v63
    buffer_store_dwordx4 v[64:67], v13, s[40:43], s101 offen offset:1024 sc1
    buffer_store_dwordx4 v[68:71], v13, s[40:43], s101 offen offset:1536 sc1
    v_cvt_pk_bf16_f32 v80, v32, v33
    s_waitcnt lgkmcnt(10)
    v_mfma_f32_32x32x16_bf16 v[16:31], v[104:107], v[144:147], v[16:31]
    ds_read_b64_tr_b16 v[104:105], v93 offset:53248
    ds_read_b64_tr_b16 v[106:107], v93 offset:53760
    v_cvt_pk_bf16_f32 v81, v34, v35
    v_cvt_pk_bf16_f32 v82, v36, v37
    v_cvt_pk_bf16_f32 v83, v38, v39
    v_cvt_pk_bf16_f32 v84, v40, v41
    v_cvt_pk_bf16_f32 v85, v42, v43
    v_cvt_pk_bf16_f32 v86, v44, v45
    v_cvt_pk_bf16_f32 v87, v46, v47
    buffer_store_dwordx4 v[80:83], v12, s[40:43], s101 offen sc1
    buffer_store_dwordx4 v[84:87], v12, s[40:43], s74 offen sc1
    s_waitcnt lgkmcnt(10)
    v_mfma_f32_32x32x16_bf16 v[16:31], v[108:111], v[148:151], v[16:31]
    ds_read_b64_tr_b16 v[108:109], v93 offset:55296
    ds_read_b64_tr_b16 v[110:111], v93 offset:55808
    s_waitcnt lgkmcnt(10)
    v_mfma_f32_32x32x16_bf16 v[16:31], v[112:115], v[152:155], v[16:31]
    ds_read_b64_tr_b16 v[112:113], v93 offset:57344
    ds_read_b64_tr_b16 v[114:115], v93 offset:57856
    s_waitcnt lgkmcnt(10)
    v_mfma_f32_32x32x16_bf16 v[16:31], v[116:119], v[156:159], v[16:31]
    ds_read_b64_tr_b16 v[116:117], v93 offset:59392
    ds_read_b64_tr_b16 v[118:119], v93 offset:59904
    s_waitcnt lgkmcnt(10)
    v_mfma_f32_32x32x16_bf16 v[16:31], v[96:99], v[160:163], v[16:31]
    ds_read_b64_tr_b16 v[96:97], v93 offset:61440
    ds_read_b64_tr_b16 v[98:99], v93 offset:61952
    s_waitcnt lgkmcnt(10)
    v_mfma_f32_32x32x16_bf16 v[16:31], v[100:103], v[164:167], v[16:31]
    ds_read_b64_tr_b16 v[100:101], v93 offset:63488
    ds_read_b64_tr_b16 v[102:103], v93 offset:64000
    s_waitcnt vmcnt(4)
    s_cmp_lg_u32 s68, 0
    s_cbranch_scc1 Lpc13
    s_waitcnt vmcnt(13)
    s_mov_b32 s91, 0
Lsp14:
    v_readfirstlane_b32 s75, v14
    s_nop 0
    s_cmp_ge_u32 s75, 1
    s_cbranch_scc1 Lsd15
    buffer_load_dword v14, off, s[52:55], 0 sc1
    s_add_u32 s91, s91, 1
    s_cmp_lt_u32 s91, 400000
    s_waitcnt vmcnt(0)
    s_cbranch_scc1 Lsp14
Lsd15:
Lpc13:
    s_barrier
    s_waitcnt lgkmcnt(10)
    v_mfma_f32_32x32x16_bf16 v[16:31], v[104:107], v[168:171], v[16:31]
    ds_read_b64_tr_b16 v[104:105], v94 offset:0
    ds_read_b64_tr_b16 v[106:107], v94 offset:512
    v_dot2_f32_bf16 v64, v72, v88, 0
    v_dot2_f32_bf16 v66, v76, v88, 0
    v_dot2_f32_bf16 v64, v73, v89, v64
    v_dot2_f32_bf16 v66, v77, v89, v66
    v_dot2_f32_bf16 v64, v74, v90, v64
    v_dot2_f32_bf16 v66, v78, v90, v66
    v_dot2_f32_bf16 v64, v75, v91, v64
    v_dot2_f32_bf16 v66, v79, v91, v66
    s_waitcnt lgkmcnt(10)
    v_mfma_f32_32x32x16_bf16 v[16:31], v[108:111], v[172:175], v[16:31]
    ds_read_b64_tr_b16 v[108:109], v94 offset:2048
    ds_read_b64_tr_b16 v[110:111], v94 offset:2560
    s_waitcnt lgkmcnt(10)
    v_mfma_f32_32x32x16_bf16 v[16:31], v[112:115], v[176:179], v[16:31]
    ds_read_b64_tr_b16 v[112:113], v94 offset:4096
    ds_read_b64_tr_b16 v[114:115], v94 offset:4608
    v_add_f32_dpp v64, v64, v64 quad_perm:[1,0,3,2] row_mask:0xf bank_mask:0xf
    v_add_f32_dpp v66, v66, v66 quad_perm:[1,0,3,2] row_mask:0xf bank_mask:0xf
    s_nop 0
    v_add_f32_dpp v64, v64, v64 quad_perm:[2,3,0,1] row_mask:0xf bank_mask:0xf
    s_waitcnt lgkmcnt(10)
    v_mfma_f32_32x32x16_bf16 v[16:31], v[116:119], v[180:183], v[16:31]
    ds_read_b64_tr_b16 v[116:117], v94 offset:6144
    ds_read_b64_tr_b16 v[118:119], v94 offset:6656
    v_add_f32_dpp v66, v66, v66 quad_perm:[2,3,0,1] row_mask:0xf bank_mask:0xf
    v_add_f32_dpp v64, v64, v64 row_half_mirror row_mask:0xf bank_mask:0xf
    s_waitcnt lgkmcnt(10)
    v_mfma_f32_32x32x16_bf16 v[16:31], v[96:99], v[184:187], v[16:31]
    ds_read_b64_tr_b16 v[96:97], v94 offset:8192
    ds_read_b64_tr_b16 v[98:99], v94 offset:8704
    v_add_f32_dpp v66, v66, v66 row_half_mirror row_mask:0xf bank_mask:0xf
    v_add_f32_dpp v64, v64, v64 row_mirror row_mask:0xf bank_mask:0xf
    s_waitcnt lgkmcnt(10)
    v_mfma_f32_32x32x16_bf16 v[16:31], v[100:103], v[188:191], v[16:31]
    ds_read_b64_tr_b16 v[100:101], v94 offset:10240
    ds_read_b64_tr_b16 v[102:103], v94 offset:10752
    v_add_f32_dpp v66, v66, v66 row_mirror row_mask:0xf bank_mask:0xf
    v_mov_b32 v65, v64
    s_waitcnt lgkmcnt(10)
    v_mfma_f32_32x32x16_bf16 v[16:31], v[104:107], v[192:195], v[16:31]
    ds_read_b64_tr_b16 v[104:105], v94 offset:12288
    ds_read_b64_tr_b16 v[106:107], v94 offset:12800
    v_mov_b32 v67, v66
    v_permlane16_swap_b32 v64, v65
    s_waitcnt lgkmcnt(10)
    v_mfma_f32_32x32x16_bf16 v[16:31], v[108:111], v[196:199], v[16:31]
    ds_read_b64_tr_b16 v[108:109], v94 offset:14336
    ds_read_b64_tr_b16 v[110:111], v94 offset:14848
    v_permlane16_swap_b32 v66, v67
    v_add_f32 v64, v64, v65
    s_waitcnt lgkmcnt(10)
    v_mfma_f32_32x32x16_bf16 v[16:31], v[112:115], v[200:203], v[16:31]
    ds_read_b64_tr_b16 v[112:113], v94 offset:16384
    ds_read_b64_tr_b16 v[114:115], v94 offset:16896
    v_add_f32 v66, v66, v67
    v_mov_b32 v65, v64
    v_mov_b32 v67, v66
    s_waitcnt lgkmcnt(10)
    v_mfma_f32_32x32x16_bf16 v[16:31], v[116:119], v[204:207], v[16:31]
    ds_read_b64_tr_b16 v[116:117], v94 offset:18432
    ds_read_b64_tr_b16 v[118:119], v94 offset:18944
    v_permlane32_swap_b32 v64, v65
    v_permlane32_swap_b32 v66, v67
    s_waitcnt vmcnt(0)
    s_barrier
    s_cmp_lg_u32 s68, 1
    s_cbranch_scc1 Llf16
    v_mov_b32 v9, s6
    s_mov_b64 exec, 1
    buffer_store_dword v9, off, s[40:43], s7
    s_mov_b64 exec, -1
Llf16:
    s_waitcnt lgkmcnt(10)
    v_mfma_f32_32x32x16_bf16 v[16:31], v[96:99], v[208:211], v[16:31]
    ds_read_b64_tr_b16 v[96:97], v94 offset:20480
    ds_read_b64_tr_b16 v[98:99], v94 offset:20992
    v_add_f32 v64, v64, v65
    v_add_f32 v66, v66, v67
    s_waitcnt lgkmcnt(10)
    v_mfma_f32_32x32x16_bf16 v[16:31], v[100:103], v[212:215], v[16:31]
    ds_read_b64_tr_b16 v[100:101], v94 offset:22528
    ds_read_b64_tr_b16 v[102:103], v94 offset:23040
    v_cvt_pk_bf16_f32 v64, v64, v64
    v_cvt_pk_bf16_f32 v66, v66, v66
    s_waitcnt lgkmcnt(10)
    v_mfma_f32_32x32x16_bf16 v[16:31], v[104:107], v[216:219], v[16:31]
    ds_read_b64_tr_b16 v[104:105], v94 offset:24576
    ds_read_b64_tr_b16 v[106:107], v94 offset:25088
    v_and_b32 v64, 0xffff0000, v64
    v_and_b32 v66, 0xffff0000, v66
    s_waitcnt lgkmcnt(10)
    v_mfma_f32_32x32x16_bf16 v[16:31], v[108:111], v[220:223], v[16:31]
    ds_read_b64_tr_b16 v[108:109], v94 offset:26624
    ds_read_b64_tr_b16 v[110:111], v94 offset:27136
    v_mul_f32 v64, s82, v64
    v_mul_f32 v66, s82, v66
    s_waitcnt lgkmcnt(10)
    v_mfma_f32_32x32x16_bf16 v[16:31], v[112:115], v[224:227], v[16:31]
    ds_read_b64_tr_b16 v[112:113], v94 offset:28672
    ds_read_b64_tr_b16 v[114:115], v94 offset:29184
    v_exp_f32 v64, v64
    v_exp_f32 v66, v66
    s_waitcnt lgkmcnt(10)
    v_mfma_f32_32x32x16_bf16 v[16:31], v[116:119], v[228:231], v[16:31]
    ds_read_b64_tr_b16 v[116:117], v94 offset:30720
    ds_read_b64_tr_b16 v[118:119], v94 offset:31232
    v_add_f32 v64, 1.0, v64
    v_add_f32 v66, 1.0, v66
    v_rcp_f32 v64, v64
    s_waitcnt lgkmcnt(10)
    v_mfma_f32_32x32x16_bf16 v[16:31], v[96:99], v[232:235], v[16:31]
    v_rcp_f32 v66, v66
    v_cvt_pk_bf16_f32 v64, v64, v64
    s_waitcnt lgkmcnt(0)
    s_barrier
    v_mfma_f32_32x32x16_bf16 v[16:31], v[100:103], v[236:239], v[16:31]
    v_cvt_pk_bf16_f32 v66, v66, v66
    v_and_b32 v64, 0xffff0000, v64
    v_mfma_f32_32x32x16_bf16 v[16:31], v[104:107], v[240:243], v[16:31]
    v_and_b32 v66, 0xffff0000, v66
    v_sub_f32 v65, 1.0, v64
    v_mfma_f32_32x32x16_bf16 v[16:31], v[108:111], v[244:247], v[16:31]
    v_sub_f32 v67, 1.0, v66
    v_cvt_pk_bf16_f32 v65, v65, v65
    v_mfma_f32_32x32x16_bf16 v[16:31], v[112:115], v[248:251], v[16:31]
    v_cvt_pk_bf16_f32 v67, v67, v67
    v_and_b32 v65, 0xffff0000, v65
    v_mfma_f32_32x32x16_bf16 v[16:31], v[116:119], v[252:255], v[16:31]
    v_and_b32 v67, 0xffff0000, v67
    s_lshl_b32 s72, s100, 3
    s_add_u32 s72, s72, 0xc00000
    s_mov_b64 exec, 1
    buffer_store_dwordx4 v[64:67], off, s[40:43], s72 sc1
    s_mov_b64 exec, -1
    v_and_b32 v10, 27, v1
    v_cmp_eq_u32 vcc, 16, v10
    v_mov_b32 v11, 0x3f803f80
    v_mov_b64 v[176:177], 0
    v_mov_b64 v[178:179], 0
    v_cndmask_b32 v104, 0, v11, vcc
    v_cndmask_b32 v105, 0, v11, vcc
    v_cvt_pk_bf16_f32 v128, v16, v17
    v_cvt_pk_bf16_f32 v129, v18, v19
    v_cvt_pk_bf16_f32 v130, v20, v21
    v_cvt_pk_bf16_f32 v131, v22, v23
    v_cvt_pk_bf16_f32 v132, v24, v25
    v_cvt_pk_bf16_f32 v133, v26, v27
    v_cvt_pk_bf16_f32 v134, v28, v29
    v_cvt_pk_bf16_f32 v135, v30, v31
    v_mfma_f32_32x32x16_bf16 v[32:47], v[120:123], v[128:131], 0
    s_nop 0
    v_mfma_f32_32x32x16_bf16 v[48:63], v[124:127], v[132:135], 0
    v_mfma_f32_32x32x16_bf16 v[64:79], v[176:179], v[176:179], 0
    v_mfma_f32_32x32x16_bf16 v[80:95], v[176:179], v[176:179], 0
    v_mov_b64 v[106:107], v[104:105]
    v_mov_b64 v[108:109], v[104:105]
    v_mov_b64 v[110:111], v[104:105]
    v_mov_b64 v[112:113], v[104:105]
    v_mov_b64 v[114:115], v[104:105]
    v_mov_b64 v[116:117], v[104:105]
    v_mov_b64 v[118:119], v[104:105]
    v_and_b32 v9, 31, v1
    v_lshlrev_b32 v9, 2, v9
    buffer_load_dword v14, v9, s[40:43], s9 offen sc1
    v_max3_f32 v136, v32, v33, v34
    v_max3_f32 v144, v48, v49, v50
    v_max3_f32 v138, v40, v41, v42
    v_max3_f32 v146, v56, v57, v58
    v_max3_f32 v137, v35, v36, v37
    v_max3_f32 v145, v51, v52, v53
    v_max3_f32 v139, v43, v44, v45
    v_max3_f32 v147, v59, v60, v61
    v_max3_f32 v136, v38, v39, v136
    v_max3_f32 v144, v54, v55, v144
    v_max3_f32 v138, v46, v47, v138
    v_max3_f32 v146, v62, v63, v146
    v_max_f32 v136, v136, v137
    v_max_f32 v144, v144, v145
    v_max_f32 v138, v138, v139
    v_max_f32 v146, v146, v147
    s_nop 0
    v_permlane32_swap_b32 v136, v138
    v_permlane32_swap_b32 v144, v146
    v_max_f32 v136, v136, v138
    v_max_f32 v144, v144, v146
    v_mul_f32 v136, s82, v136
    v_mul_f32 v144, s82, v144
    v_mov_b32 v138, v136
    v_mov_b32 v146, v144
    s_nop 0
    v_permlane32_swap_b32 v136, v138
    v_permlane32_swap_b32 v144, v146
    v_mov_b32 v137, v136
    v_mov_b32 v145, v144
    v_mov_b32 v139, v138
    v_mov_b32 v147, v146
    v_pk_fma_f32 v[32:33], v[32:33], s[80:81], v[136:137]
    v_pk_fma_f32 v[48:49], v[48:49], s[80:81], v[144:145]
    v_pk_fma_f32 v[34:35], v[34:35], s[80:81], v[136:137]
    v_pk_fma_f32 v[50:51], v[50:51], s[80:81], v[144:145]
    v_pk_fma_f32 v[36:37], v[36:37], s[80:81], v[136:137]
    v_pk_fma_f32 v[52:53], v[52:53], s[80:81], v[144:145]
    v_pk_fma_f32 v[38:39], v[38:39], s[80:81], v[136:137]
    v_pk_fma_f32 v[54:55], v[54:55], s[80:81], v[144:145]
    v_pk_fma_f32 v[40:41], v[40:41], s[80:81], v[138:139]
    v_pk_fma_f32 v[56:57], v[56:57], s[80:81], v[146:147]
    v_pk_fma_f32 v[42:43], v[42:43], s[80:81], v[138:139]
    v_pk_fma_f32 v[58:59], v[58:59], s[80:81], v[146:147]
    v_pk_fma_f32 v[44:45], v[44:45], s[80:81], v[138:139]
    v_pk_fma_f32 v[60:61], v[60:61], s[80:81], v[146:147]
    v_pk_fma_f32 v[46:47], v[46:47], s[80:81], v[138:139]
    v_pk_fma_f32 v[62:63], v[62:63], s[80:81], v[146:147]
    s_waitcnt vmcnt(0)
    s_mov_b32 s91, 0
Lsp17:
    v_cmp_ne_u32 vcc, s6, v14
    s_nop 0
    s_cbranch_vccz Lsd18
    s_add_u32 s91, s91, 1
    s_cmp_lt_u32 s91, 24
    s_cbranch_scc1 Lsn19
    s_lshl_b32 s73, s69, 8
    s_add_u32 s73, s73, 0xc10000
    s_cmp_lg_u32 s91, 24
    s_cbranch_scc1 Lsr20
    s_cmp_lg_u32 s68, 0
    s_cbranch_scc1 Lsr20
    v_mov_b32 v14, 1
    s_mov_b64 exec, 1
    buffer_atomic_add v14, off, s[40:43], s73 sc1
    s_mov_b64 exec, -1
Lsr20:
    s_sleep 16
    buffer_load_dword v14, off, s[40:43], s73 sc1
    s_waitcnt vmcnt(0)
    v_readfirstlane_b32 s75, v14
    s_nop 0
    s_cmp_ge_u32 s75, 32
    s_cselect_b32 s6, 0, s6
    s_cbranch_scc1 Lsd18
Lsn19:
    buffer_load_dword v14, v9, s[40:43], s9 offen sc1
    s_cmp_lt_u32 s91, 400000
    s_waitcnt vmcnt(0)
    s_cbranch_scc1 Lsp17
Lsd18:
    s_lshl_b32 s76, s88, 17
    s_lshl_b32 s72, s68, 11
    s_add_u32 s76, s76, s72
    s_lshl_b32 s72, s88, 16
    s_lshl_b32 s73, s90, 10
    s_add_u32 s72, s72, s73
    s_add_u32 s72, s72, 0x400000
    s_xor_b32 s73, s72, 1024
    buffer_load_dwordx4 v[120:123], v2, s[40:43], s72 offen sc1
    buffer_load_dwordx4 v[124:127], v2, s[40:43], s73 offen sc1
    s_lshl_b32 s72, s88, 17
    buffer_load_dwordx4 v[184:187], v2, s[40:43], s72 offen sc1
    s_add_u32 m0, s85, 0
    s_add_u32 s72, s76, 0
    buffer_load_dwordx4 v2, s[40:43], s72 offen sc1 lds
    buffer_load_dwordx4 v2, s[40:43], s72 offen offset:1024 sc1 lds
    s_add_u32 m0, s85, 8192
    s_add_u32 s72, s76, 16384
    buffer_load_dwordx4 v2, s[40:43], s72 offen sc1 lds
    buffer_load_dwordx4 v2, s[40:43], s72 offen offset:1024 sc1 lds
    v_exp_f32 v32, v32
    v_exp_f32 v48, v48
    v_exp_f32 v33, v33
    v_exp_f32 v49, v49
    v_exp_f32 v34, v34
    v_exp_f32 v50, v50
    v_exp_f32 v35, v35
    v_exp_f32 v51, v51
    v_exp_f32 v36, v36
    v_exp_f32 v52, v52
    v_exp_f32 v37, v37
    v_exp_f32 v53, v53
    v_exp_f32 v38, v38
    v_exp_f32 v54, v54
    v_exp_f32 v39, v39
    v_exp_f32 v55, v55
    v_exp_f32 v40, v40
    v_exp_f32 v56, v56
    v_exp_f32 v41, v41
    v_exp_f32 v57, v57
    v_exp_f32 v42, v42
    v_exp_f32 v58, v58
    v_exp_f32 v43, v43
    v_exp_f32 v59, v59
    v_exp_f32 v44, v44
    v_exp_f32 v60, v60
    v_exp_f32 v45, v45
    v_exp_f32 v61, v61
    v_exp_f32 v46, v46
    v_exp_f32 v62, v62
    v_exp_f32 v47, v47
    v_exp_f32 v63, v63
    v_pk_add_f32 v[136:137], v[32:33], v[34:35]
    v_pk_add_f32 v[144:145], v[48:49], v[50:51]
    v_pk_add_f32 v[138:139], v[36:37], v[38:39]
    v_pk_add_f32 v[146:147], v[52:53], v[54:55]
    v_pk_add_f32 v[140:141], v[40:41], v[42:43]
    v_pk_add_f32 v[148:149], v[56:57], v[58:59]
    v_pk_add_f32 v[142:143], v[44:45], v[46:47]
    v_pk_add_f32 v[150:151], v[60:61], v[62:63]
    v_pk_add_f32 v[136:137], v[136:137], v[138:139]
    v_pk_add_f32 v[144:145], v[144:145], v[146:147]
    v_pk_add_f32 v[140:141], v[140:141], v[142:143]
    v_pk_add_f32 v[148:149], v[148:149], v[150:151]
    v_add_f32 v136, v136, v137
    v_add_f32 v144, v144, v145
    v_add_f32 v138, v140, v141
    v_add_f32 v146, v148, v149
    s_nop 0
    v_permlane32_swap_b32 v136, v138
    v_permlane32_swap_b32 v144, v146
    v_add_f32 v136, v136, v138
    v_add_f32 v144, v144, v146
    v_rcp_f32 v136, v136
    v_rcp_f32 v144, v144
    v_mov_b32 v138, v136
    s_nop 0
    v_mov_b32 v146, v144
    v_permlane32_swap_b32 v136, v138
    s_nop 0
    v_permlane32_swap_b32 v144, v146
    v_mov_b32 v137, v136
    v_mov_b32 v145, v144
    v_mov_b32 v139, v138
    v_mov_b32 v147, v146
    v_pk_mul_f32 v[32:33], v[32:33], v[136:137]
    v_pk_mul_f32 v[48:49], v[48:49], v[144:145]
    v_pk_mul_f32 v[34:35], v[34:35], v[136:137]
    v_pk_mul_f32 v[50:51], v[50:51], v[144:145]
    v_pk_mul_f32 v[36:37], v[36:37], v[136:137]
    v_pk_mul_f32 v[52:53], v[52:53], v[144:145]
    v_pk_mul_f32 v[38:39], v[38:39], v[136:137]
    v_pk_mul_f32 v[54:55], v[54:55], v[144:145]
    v_pk_mul_f32 v[40:41], v[40:41], v[138:139]
    v_pk_mul_f32 v[56:57], v[56:57], v[146:147]
    v_pk_mul_f32 v[42:43], v[42:43], v[138:139]
    v_pk_mul_f32 v[58:59], v[58:59], v[146:147]
    v_pk_mul_f32 v[44:45], v[44:45], v[138:139]
    v_pk_mul_f32 v[60:61], v[60:61], v[146:147]
    v_pk_mul_f32 v[46:47], v[46:47], v[138:139]
    v_pk_mul_f32 v[62:63], v[62:63], v[146:147]
    s_waitcnt vmcnt(4)
    v_mfma_f32_32x32x16_bf16 v[192:207], v[184:187], v[120:123], 0
    v_mfma_f32_32x32x16_bf16 v[208:223], v[184:187], v[124:127], 0
    v_cvt_pk_bf16_f32 v152, v32, v33
    v_cvt_pk_bf16_f32 v160, v48, v49
    v_cvt_pk_bf16_f32 v153, v34, v35
    v_cvt_pk_bf16_f32 v161, v50, v51
    v_cvt_pk_bf16_f32 v154, v36, v37
    v_cvt_pk_bf16_f32 v162, v52, v53
    v_cvt_pk_bf16_f32 v155, v38, v39
    v_cvt_pk_bf16_f32 v163, v54, v55
    v_cvt_pk_bf16_f32 v156, v40, v41
    v_cvt_pk_bf16_f32 v164, v56, v57
    v_cvt_pk_bf16_f32 v157, v42, v43
    v_cvt_pk_bf16_f32 v165, v58, v59
    v_cvt_pk_bf16_f32 v158, v44, v45
    v_cvt_pk_bf16_f32 v166, v60, v61
    v_cvt_pk_bf16_f32 v159, v46, v47
    v_cvt_pk_bf16_f32 v167, v62, v63
    v_max3_f32 v10, v208, v209, v210
    v_max3_f32 v10, v211, v212, v10
    v_max3_f32 v10, v213, v214, v10
    v_max3_f32 v10, v215, v216, v10
    v_max3_f32 v10, v217, v218, v10
    v_max3_f32 v10, v219, v220, v10
    v_max3_f32 v10, v221, v222, v10
    v_max_f32 v10, v223, v10
    v_max3_f32 v9, v192, v193, v194
    v_max3_f32 v9, v195, v196, v9
    v_max3_f32 v9, v197, v198, v9
    v_max3_f32 v9, v199, v200, v9
    v_max3_f32 v9, v201, v202, v9
    v_max3_f32 v9, v203, v204, v9
    v_max3_f32 v9, v205, v206, v9
    v_max3_f32 v9, v207, v10, v9
    v_mov_b32 v10, v9
    s_nop 1
    v_permlane32_swap_b32 v9, v10
    v_max_f32 v9, v9, v10
    v_sub_f32 v16, 0, v9
    v_sub_f32 v17, 0, v9
    v_mov_b64 v[18:19], v[16:17]
    v_mov_b64 v[20:21], v[16:17]
    v_mov_b64 v[22:23], v[16:17]
    v_mov_b64 v[24:25], v[16:17]
    v_mov_b64 v[26:27], v[16:17]
    v_mov_b64 v[28:29], v[16:17]
    v_mov_b64 v[30:31], v[16:17]
    s_waitcnt vmcnt(0)
    s_barrier
L_P2:
    ds_read_b128 v[96:99], v3 offset:0
    ds_read_b128 v[100:103], v3 offset:2048
    s_mov_b64 exec, s[0:1]
    ds_read_b128 v[104:107], v4 offset:1024
    ds_read_b128 v[108:111], v4 offset:1536
    s_mov_b64 exec, -1
    s_cmp_lt_u32 s68, 4
    s_cbranch_scc1 Lcn22
    s_setprio 1
Lcn22:
    s_waitcnt lgkmcnt(3)
    v_mfma_f32_32x32x16_bf16 v[32:47], v[96:99], v[124:127], v[16:31]
    s_add_u32 m0, s85, 16384
    s_add_u32 s72, s76, 32768
    buffer_load_dwordx4 v2, s[40:43], s72 offen sc1 lds
    buffer_load_dwordx4 v2, s[40:43], s72 offen offset:1024 sc1 lds
    s_add_u32 m0, s85, 24576
    s_add_u32 s72, s76, 49152
    buffer_load_dwordx4 v2, s[40:43], s72 offen sc1 lds
    buffer_load_dwordx4 v2, s[40:43], s72 offen offset:1024 sc1 lds
    s_cmp_lg_u32 s83, 0
    s_nop 1
    s_cbranch_scc1 Lcn23
    s_lshr_b32 s72, s68, 2
    s_lshl_b32 s72, s72, 16
    s_bfe_u32 s73, s68, 0x10001
    s_lshl_b32 s73, s73, 14
    s_add_u32 s72, s72, s73
    s_and_b32 s73, s68, 1
    s_lshl_b32 s73, s73, 11
    s_add_u32 s72, s72, s73
    s_add_u32 s72, s72, 32768
    v_add_u32 v9, s72, v2
    ds_read_b128 v[192:195], v9 offset:0
    ds_read_b128 v[196:199], v9 offset:4096
    ds_read_b128 v[200:203], v9 offset:8192
    ds_read_b128 v[204:207], v9 offset:12288
    ds_read_b128 v[208:211], v9 offset:1024
    ds_read_b128 v[212:215], v9 offset:5120
    ds_read_b128 v[216:219], v9 offset:9216
    ds_read_b128 v[220:223], v9 offset:13312
Lcn23:
.p2align 3
    v_exp_f32 v32, v32
    v_exp_f32 v33, v33
    s_mov_b64 exec, s[0:1]
    ds_read_b128 v[112:115], v4 offset:3072
    ds_read_b128 v[116:119], v4 offset:3584
    s_mov_b64 exec, -1
    v_exp_f32 v34, v34
    v_exp_f32 v35, v35
    v_mfma_f32_32x32x16_bf16 v[48:63], v[96:99], v[120:123], v[16:31]
    ds_read_b128 v[96:99], v3 offset:4096
    v_exp_f32 v36, v36
    v_exp_f32 v37, v37
    v_exp_f32 v38, v38
    v_exp_f32 v39, v39
    v_exp_f32 v40, v40
    v_exp_f32 v41, v41
    s_waitcnt lgkmcnt(3)
    v_smfmac_f32_32x32x32_bf16 v[80:95], v[104:107], v[32:39], v5
    v_exp_f32 v42, v42
    v_exp_f32 v43, v43
    v_exp_f32 v44, v44
    v_exp_f32 v45, v45
    v_exp_f32 v46, v46
    v_exp_f32 v47, v47
    v_exp_f32 v48, v48
    v_exp_f32 v49, v49
    v_smfmac_f32_32x32x32_bf16 v[80:95], v[108:111], v[40:47], v5
    v_exp_f32 v50, v50
    v_exp_f32 v51, v51
    v_mfma_f32_32x32x16_bf16 v[32:47], v[100:103], v[124:127], v[16:31]
    v_exp_f32 v52, v52
    v_exp_f32 v53, v53
    v_exp_f32 v54, v54
    v_exp_f32 v55, v55
    v_exp_f32 v56, v56
    v_exp_f32 v57, v57
    v_smfmac_f32_32x32x32_bf16 v[64:79], v[104:107], v[48:55], v5
    v_exp_f32 v58, v58
    v_exp_f32 v59, v59
    v_exp_f32 v60, v60
    v_exp_f32 v61, v61
    v_exp_f32 v62, v62
    v_exp_f32 v63, v63
    v_exp_f32 v32, v32
    v_exp_f32 v33, v33
    v_smfmac_f32_32x32x32_bf16 v[64:79], v[108:111], v[56:63], v5
    s_mov_b64 exec, s[0:1]
    ds_read_b128 v[104:107], v4 offset:5120
    ds_read_b128 v[108:111], v4 offset:5632
    s_mov_b64 exec, -1
    v_exp_f32 v34, v34
    v_exp_f32 v35, v35
    v_mfma_f32_32x32x16_bf16 v[48:63], v[100:103], v[120:123], v[16:31]
    ds_read_b128 v[100:103], v3 offset:6144
    v_exp_f32 v36, v36
    v_exp_f32 v37, v37
    v_exp_f32 v38, v38
    s_cmp_lg_u32 s83, 0
    s_cbranch_scc1 Lcn24
    s_lshl_b32 s72, s3, 2
    s_lshr_b32 s73, s68, 1
    s_add_u32 s72, s72, s73
    s_lshl_b32 s72, s72, 16
    s_lshl_b32 s73, s87, 9
    s_add_u32 s72, s72, s73
    s_lshl_b32 s73, s11, 15
    s_add_u32 s72, s72, s73
    s_add_u32 s72, s72, 0xa00000
    v_lshlrev_b32 v9, 3, v1
    v_add_f32 v192, v192, v200
    v_add_f32 v193, v193, v201
    v_add_f32 v194, v194, v202
    v_add_f32 v195, v195, v203
    v_add_f32 v196, v196, v204
    v_add_f32 v197, v197, v205
    v_add_f32 v198, v198, v206
    v_add_f32 v199, v199, v207
    v_add_f32 v192, v192, v196
    v_add_f32 v193, v193, v197
    v_add_f32 v194, v194, v198
    v_add_f32 v195, v195, v199
    v_add_f32 v208, v208, v216
    v_add_f32 v209, v209, v217
    v_add_f32 v210, v210, v218
    v_add_f32 v211, v211, v219
    v_add_f32 v212, v212, v220
    v_add_f32 v213, v213, v221
    v_add_f32 v214, v214, v222
    v_add_f32 v215, v215, v223
    v_add_f32 v208, v208, v212
    v_add_f32 v209, v209, v213
    v_add_f32 v210, v210, v214
    v_add_f32 v211, v211, v215
    buffer_store_dwordx2 v[192:193], v9, s[40:43], s72 offen sc1
    s_add_u32 s72, s72, 8192
    buffer_store_dwordx2 v[194:195], v9, s[40:43], s72 offen sc1
    s_add_u32 s72, s72, 8192
    buffer_store_dwordx2 v[208:209], v9, s[40:43], s72 offen sc1
    s_add_u32 s72, s72, 8192
    buffer_store_dwordx2 v[210:211], v9, s[40:43], s72 offen sc1
Lcn24:
    s_cmp_eq_u32 s83, 0
    s_cbranch_scc1 Lcn25
    s_add_u32 s72, s101, 0x600000
    s_add_u32 s73, s72, 0x20000
    buffer_store_dwordx4 v[152:155], v2, s[40:43], s72 offen sc1
    buffer_store_dwordx4 v[156:159], v2, s[40:43], s72 offen offset:1024 sc1
    buffer_store_dwordx4 v[160:163], v2, s[40:43], s73 offen sc1
    buffer_store_dwordx4 v[164:167], v2, s[40:43], s73 offen offset:1024 sc1
Lcn25:
    v_exp_f32 v39, v39
    v_exp_f32 v40, v40
    v_exp_f32 v41, v41
    s_waitcnt lgkmcnt(4)
    v_smfmac_f32_32x32x32_bf16 v[80:95], v[112:115], v[32:39], v5
    v_exp_f32 v42, v42
    v_exp_f32 v43, v43
    v_exp_f32 v44, v44
    v_exp_f32 v45, v45
    v_exp_f32 v46, v46
    v_exp_f32 v47, v47
    v_exp_f32 v48, v48
    v_exp_f32 v49, v49
    v_smfmac_f32_32x32x32_bf16 v[80:95], v[116:119], v[40:47], v5
    v_exp_f32 v50, v50
    v_exp_f32 v51, v51
    s_waitcnt lgkmcnt(3)
    v_mfma_f32_32x32x16_bf16 v[32:47], v[96:99], v[124:127], v[16:31]
    v_exp_f32 v52, v52
    v_exp_f32 v53, v53
    v_exp_f32 v54, v54
    s_cmp_lt_u32 s68, 4
    s_cbranch_scc1 Lcn26
    s_setprio 0
Lcn26:
    v_exp_f32 v55, v55
    v_exp_f32 v56, v56
    v_exp_f32 v57, v57
    v_smfmac_f32_32x32x32_bf16 v[64:79], v[112:115], v[48:55], v5
    v_exp_f32 v58, v58
    v_exp_f32 v59, v59
    v_exp_f32 v60, v60
    v_exp_f32 v61, v61
    v_exp_f32 v62, v62
    v_exp_f32 v63, v63
    v_exp_f32 v32, v32
    v_exp_f32 v33, v33
    v_smfmac_f32_32x32x32_bf16 v[64:79], v[116:119], v[56:63], v5
    s_mov_b64 exec, s[0:1]
    ds_read_b128 v[112:115], v4 offset:7168
    ds_read_b128 v[116:119], v4 offset:7680
    s_mov_b64 exec, -1
    v_exp_f32 v34, v34
    v_exp_f32 v35, v35
    v_mfma_f32_32x32x16_bf16 v[48:63], v[96:99], v[120:123], v[16:31]
    ds_read_b128 v[96:99], v3 offset:8192
    v_exp_f32 v36, v36
    v_exp_f32 v37, v37
    v_exp_f32 v38, v38
    s_cmp_lt_u32 s68, 4
    s_cbranch_scc1 Lcn27
    s_setprio 1
Lcn27:
    v_exp_f32 v39, v39
    v_exp_f32 v40, v40
    v_exp_f32 v41, v41
    s_waitcnt lgkmcnt(4)
    v_smfmac_f32_32x32x32_bf16 v[80:95], v[104:107], v[32:39], v5
    v_exp_f32 v42, v42
    v_exp_f32 v43, v43
    v_exp_f32 v44, v44
    v_exp_f32 v45, v45
    v_exp_f32 v46, v46
    v_exp_f32 v47, v47
    v_exp_f32 v48, v48
    v_exp_f32 v49, v49
    v_smfmac_f32_32x32x32_bf16 v[80:95], v[108:111], v[40:47], v5
    v_exp_f32 v50, v50
    v_exp_f32 v51, v51
    s_waitcnt lgkmcnt(3)
    v_mfma_f32_32x32x16_bf16 v[32:47], v[100:103], v[124:127], v[16:31]
    v_exp_f32 v52, v52
    v_exp_f32 v53, v53
    v_exp_f32 v54, v54
    v_exp_f32 v55, v55
    v_exp_f32 v56, v56
    v_exp_f32 v57, v57
    v_smfmac_f32_32x32x32_bf16 v[64:79], v[104:107], v[48:55], v5
    v_exp_f32 v58, v58
    v_exp_f32 v59, v59
    v_exp_f32 v60, v60
    v_exp_f32 v61, v61
    v_exp_f32 v62, v62
    v_exp_f32 v63, v63
    v_exp_f32 v32, v32
    v_exp_f32 v33, v33
    v_smfmac_f32_32x32x32_bf16 v[64:79], v[108:111], v[56:63], v5
    s_mov_b64 exec, s[0:1]
    ds_read_b128 v[104:107], v4 offset:9216
    ds_read_b128 v[108:111], v4 offset:9728
    s_mov_b64 exec, -1
    v_exp_f32 v34, v34
    v_exp_f32 v35, v35
    v_mfma_f32_32x32x16_bf16 v[48:63], v[100:103], v[120:123], v[16:31]
    ds_read_b128 v[100:103], v3 offset:10240
    v_exp_f32 v36, v36
    v_exp_f32 v37, v37
    v_exp_f32 v38, v38
    s_waitcnt vmcnt(4)
    s_barrier
    v_exp_f32 v39, v39
    v_exp_f32 v40, v40
    v_exp_f32 v41, v41
    s_waitcnt lgkmcnt(4)
    v_smfmac_f32_32x32x32_bf16 v[80:95], v[112:115], v[32:39], v5
    v_exp_f32 v42, v42
    v_exp_f32 v43, v43
    v_exp_f32 v44, v44
    v_exp_f32 v45, v45
    v_exp_f32 v46, v46
    v_exp_f32 v47, v47
    v_exp_f32 v48, v48
    v_exp_f32 v49, v49
    v_smfmac_f32_32x32x32_bf16 v[80:95], v[116:119], v[40:47], v5
    v_exp_f32 v50, v50
    v_exp_f32 v51, v51
    s_waitcnt lgkmcnt(3)
    v_mfma_f32_32x32x16_bf16 v[32:47], v[96:99], v[124:127], v[16:31]
    v_exp_f32 v52, v52
    v_exp_f32 v53, v53
    v_exp_f32 v54, v54
    s_add_u32 m0, s85, 32768
    s_add_u32 s72, s76, 65536
    buffer_load_dwordx4 v2, s[40:43], s72 offen sc1 lds
    buffer_load_dwordx4 v2, s[40:43], s72 offen offset:1024 sc1 lds
    s_cmp_lt_u32 s68, 4
    s_cbranch_scc1 Lcn28
    s_setprio 0
Lcn28:
    v_exp_f32 v55, v55
    v_exp_f32 v56, v56
    v_exp_f32 v57, v57
    v_smfmac_f32_32x32x32_bf16 v[64:79], v[112:115], v[48:55], v5
    v_exp_f32 v58, v58
    v_exp_f32 v59, v59
    v_exp_f32 v60, v60
    v_exp_f32 v61, v61
    v_exp_f32 v62, v62
    v_exp_f32 v63, v63
    v_exp_f32 v32, v32
    v_exp_f32 v33, v33
    v_smfmac_f32_32x32x32_bf16 v[64:79], v[116:119], v[56:63], v5
    s_mov_b64 exec, s[0:1]
    ds_read_b128 v[112:115], v4 offset:11264
    ds_read_b128 v[116:119], v4 offset:11776
    s_mov_b64 exec, -1
    v_exp_f32 v34, v34
    v_exp_f32 v35, v35
    v_mfma_f32_32x32x16_bf16 v[48:63], v[96:99], v[120:123], v[16:31]
    ds_read_b128 v[96:99], v3 offset:12288
    v_exp_f32 v36, v36
    v_exp_f32 v37, v37
    v_exp_f32 v38, v38
    s_add_u32 m0, s85, 40960
    s_add_u32 s72, s76, 81920
    buffer_load_dwordx4 v2, s[40:43], s72 offen sc1 lds
    buffer_load_dwordx4 v2, s[40:43], s72 offen offset:1024 sc1 lds
    s_cmp_lt_u32 s68, 4
    s_cbranch_scc1 Lcn29
    s_setprio 1
Lcn29:
    v_exp_f32 v39, v39
    v_exp_f32 v40, v40
    v_exp_f32 v41, v41
    s_waitcnt lgkmcnt(4)
    v_smfmac_f32_32x32x32_bf16 v[80:95], v[104:107], v[32:39], v5
    v_exp_f32 v42, v42
    v_exp_f32 v43, v43
    v_exp_f32 v44, v44
    v_exp_f32 v45, v45
    v_exp_f32 v46, v46
    v_exp_f32 v47, v47
    v_exp_f32 v48, v48
    v_exp_f32 v49, v49
    v_smfmac_f32_32x32x32_bf16 v[80:95], v[108:111], v[40:47], v5
    v_exp_f32 v50, v50
    v_exp_f32 v51, v51
    s_waitcnt lgkmcnt(3)
    v_mfma_f32_32x32x16_bf16 v[32:47], v[100:103], v[124:127], v[16:31]
    v_exp_f32 v52, v52
    v_exp_f32 v53, v53
    v_exp_f32 v54, v54
    s_add_u32 m0, s85, 49152
    s_add_u32 s72, s76, 98304
    buffer_load_dwordx4 v2, s[40:43], s72 offen sc1 lds
    buffer_load_dwordx4 v2, s[40:43], s72 offen offset:1024 sc1 lds
    v_exp_f32 v55, v55
    v_exp_f32 v56, v56
    v_exp_f32 v57, v57
    v_smfmac_f32_32x32x32_bf16 v[64:79], v[104:107], v[48:55], v5
    v_exp_f32 v58, v58
    v_exp_f32 v59, v59
    v_exp_f32 v60, v60
    v_exp_f32 v61, v61
    v_exp_f32 v62, v62
    v_exp_f32 v63, v63
    v_exp_f32 v32, v32
    v_exp_f32 v33, v33
    v_smfmac_f32_32x32x32_bf16 v[64:79], v[108:111], v[56:63], v5
    s_mov_b64 exec, s[0:1]
    ds_read_b128 v[104:107], v4 offset:13312
    ds_read_b128 v[108:111], v4 offset:13824
    s_mov_b64 exec, -1
    v_exp_f32 v34, v34
    v_exp_f32 v35, v35
    v_mfma_f32_32x32x16_bf16 v[48:63], v[100:103], v[120:123], v[16:31]
    ds_read_b128 v[100:103], v3 offset:14336
    v_exp_f32 v36, v36
    v_exp_f32 v37, v37
    v_exp_f32 v38, v38
    s_add_u32 m0, s85, 57344
    s_add_u32 s72, s76, 114688
    buffer_load_dwordx4 v2, s[40:43], s72 offen sc1 lds
    buffer_load_dwordx4 v2, s[40:43], s72 offen offset:1024 sc1 lds
    v_exp_f32 v39, v39
    v_exp_f32 v40, v40
    v_exp_f32 v41, v41
    s_waitcnt lgkmcnt(4)
    v_smfmac_f32_32x32x32_bf16 v[80:95], v[112:115], v[32:39], v5
    v_exp_f32 v42, v42
    v_exp_f32 v43, v43
    v_exp_f32 v44, v44
    v_exp_f32 v45, v45
    v_exp_f32 v46, v46
    v_exp_f32 v47, v47
    v_exp_f32 v48, v48
    v_exp_f32 v49, v49
    v_smfmac_f32_32x32x32_bf16 v[80:95], v[116:119], v[40:47], v5
    v_exp_f32 v50, v50
    v_exp_f32 v51, v51
    s_waitcnt lgkmcnt(3)
    v_mfma_f32_32x32x16_bf16 v[32:47], v[96:99], v[124:127], v[16:31]
    v_exp_f32 v52, v52
    v_exp_f32 v53, v53
    v_exp_f32 v54, v54
    s_cmp_lt_u32 s68, 4
    s_cbranch_scc1 Lcn30
    s_setprio 0
Lcn30:
    v_exp_f32 v55, v55
    v_exp_f32 v56, v56
    v_exp_f32 v57, v57
    v_smfmac_f32_32x32x32_bf16 v[64:79], v[112:115], v[48:55], v5
    v_exp_f32 v58, v58
    v_exp_f32 v59, v59
    v_exp_f32 v60, v60
    v_exp_f32 v61, v61
    v_exp_f32 v62, v62
    v_exp_f32 v63, v63
    v_exp_f32 v32, v32
    v_exp_f32 v33, v33
    v_smfmac_f32_32x32x32_bf16 v[64:79], v[116:119], v[56:63], v5
    s_mov_b64 exec, s[0:1]
    ds_read_b128 v[112:115], v4 offset:15360
    ds_read_b128 v[116:119], v4 offset:15872
    s_mov_b64 exec, -1
    v_exp_f32 v34, v34
    v_exp_f32 v35, v35
    v_mfma_f32_32x32x16_bf16 v[48:63], v[96:99], v[120:123], v[16:31]
    ds_read_b128 v[96:99], v3 offset:16384
    v_exp_f32 v36, v36
    v_exp_f32 v37, v37
    v_exp_f32 v38, v38
    s_cmp_lt_u32 s68, 4
    s_cbranch_scc1 Lcn31
    s_setprio 1
Lcn31:
    v_exp_f32 v39, v39
    v_exp_f32 v40, v40
    v_exp_f32 v41, v41
    s_waitcnt lgkmcnt(4)
    v_smfmac_f32_32x32x32_bf16 v[80:95], v[104:107], v[32:39], v5
    v_exp_f32 v42, v42
    v_exp_f32 v43, v43
    v_exp_f32 v44, v44
    v_exp_f32 v45, v45
    v_exp_f32 v46, v46
    v_exp_f32 v47, v47
    v_exp_f32 v48, v48
    v_exp_f32 v49, v49
    v_smfmac_f32_32x32x32_bf16 v[80:95], v[108:111], v[40:47], v5
    v_exp_f32 v50, v50
    v_exp_f32 v51, v51
    s_waitcnt lgkmcnt(3)
    v_mfma_f32_32x32x16_bf16 v[32:47], v[100:103], v[124:127], v[16:31]
    v_exp_f32 v52, v52
    v_exp_f32 v53, v53
    v_exp_f32 v54, v54
    v_exp_f32 v55, v55
    v_exp_f32 v56, v56
    v_exp_f32 v57, v57
    v_smfmac_f32_32x32x32_bf16 v[64:79], v[104:107], v[48:55], v5
    v_exp_f32 v58, v58
    v_exp_f32 v59, v59
    v_exp_f32 v60, v60
    v_exp_f32 v61, v61
    v_exp_f32 v62, v62
    v_exp_f32 v63, v63
    v_exp_f32 v32, v32
    v_exp_f32 v33, v33
    v_smfmac_f32_32x32x32_bf16 v[64:79], v[108:111], v[56:63], v5
    s_mov_b64 exec, s[0:1]
    ds_read_b128 v[104:107], v4 offset:17408
    ds_read_b128 v[108:111], v4 offset:17920
    s_mov_b64 exec, -1
    v_exp_f32 v34, v34
    v_exp_f32 v35, v35
    v_mfma_f32_32x32x16_bf16 v[48:63], v[100:103], v[120:123], v[16:31]
    ds_read_b128 v[100:103], v3 offset:18432
    v_exp_f32 v36, v36
    v_exp_f32 v37, v37
    v_exp_f32 v38, v38
    v_exp_f32 v39, v39
    v_exp_f32 v40, v40
    v_exp_f32 v41, v41
    s_waitcnt lgkmcnt(4)
    v_smfmac_f32_32x32x32_bf16 v[80:95], v[112:115], v[32:39], v5
    v_exp_f32 v42, v42
    v_exp_f32 v43, v43
    v_exp_f32 v44, v44
    v_exp_f32 v45, v45
    v_exp_f32 v46, v46
    v_exp_f32 v47, v47
    v_exp_f32 v48, v48
    v_exp_f32 v49, v49
    v_smfmac_f32_32x32x32_bf16 v[80:95], v[116:119], v[40:47], v5
    v_exp_f32 v50, v50
    v_exp_f32 v51, v51
    s_waitcnt lgkmcnt(3)
    v_mfma_f32_32x32x16_bf16 v[32:47], v[96:99], v[124:127], v[16:31]
    v_exp_f32 v52, v52
    v_exp_f32 v53, v53
    v_exp_f32 v54, v54
    s_cmp_lt_u32 s68, 4
    s_cbranch_scc1 Lcn32
    s_setprio 0
Lcn32:
    v_exp_f32 v55, v55
    v_exp_f32 v56, v56
    v_exp_f32 v57, v57
    v_smfmac_f32_32x32x32_bf16 v[64:79], v[112:115], v[48:55], v5
    v_exp_f32 v58, v58
    v_exp_f32 v59, v59
    v_exp_f32 v60, v60
    v_exp_f32 v61, v61
    v_exp_f32 v62, v62
    v_exp_f32 v63, v63
    v_exp_f32 v32, v32
    v_exp_f32 v33, v33
    v_smfmac_f32_32x32x32_bf16 v[64:79], v[116:119], v[56:63], v5
    s_mov_b64 exec, s[0:1]
    ds_read_b128 v[112:115], v4 offset:19456
    ds_read_b128 v[116:119], v4 offset:19968
    s_mov_b64 exec, -1
    v_exp_f32 v34, v34
    v_exp_f32 v35, v35
    v_mfma_f32_32x32x16_bf16 v[48:63], v[96:99], v[120:123], v[16:31]
    ds_read_b128 v[96:99], v3 offset:20480
    v_exp_f32 v36, v36
    v_exp_f32 v37, v37
    v_exp_f32 v38, v38
    s_cmp_lt_u32 s68, 4
    s_cbranch_scc1 Lcn33
    s_setprio 1
Lcn33:
    v_exp_f32 v39, v39
    v_exp_f32 v40, v40
    v_exp_f32 v41, v41
    s_waitcnt lgkmcnt(4)
    v_smfmac_f32_32x32x32_bf16 v[80:95], v[104:107], v[32:39], v5
    v_exp_f32 v42, v42
    v_exp_f32 v43, v43
    v_exp_f32 v44, v44
    v_exp_f32 v45, v45
    v_exp_f32 v46, v46
    v_exp_f32 v47, v47
    v_exp_f32 v48, v48
    v_exp_f32 v49, v49
    v_smfmac_f32_32x32x32_bf16 v[80:95], v[108:111], v[40:47], v5
    v_exp_f32 v50, v50
    v_exp_f32 v51, v51
    s_waitcnt lgkmcnt(3)
    v_mfma_f32_32x32x16_bf16 v[32:47], v[100:103], v[124:127], v[16:31]
    v_exp_f32 v52, v52
    v_exp_f32 v53, v53
    v_exp_f32 v54, v54
    v_exp_f32 v55, v55
    v_exp_f32 v56, v56
    v_exp_f32 v57, v57
    v_smfmac_f32_32x32x32_bf16 v[64:79], v[104:107], v[48:55], v5
    v_exp_f32 v58, v58
    v_exp_f32 v59, v59
    v_exp_f32 v60, v60
    v_exp_f32 v61, v61
    v_exp_f32 v62, v62
    v_exp_f32 v63, v63
    v_exp_f32 v32, v32
    v_exp_f32 v33, v33
    v_smfmac_f32_32x32x32_bf16 v[64:79], v[108:111], v[56:63], v5
    s_mov_b64 exec, s[0:1]
    ds_read_b128 v[104:107], v4 offset:21504
    ds_read_b128 v[108:111], v4 offset:22016
    s_mov_b64 exec, -1
    v_exp_f32 v34, v34
    v_exp_f32 v35, v35
    v_mfma_f32_32x32x16_bf16 v[48:63], v[100:103], v[120:123], v[16:31]
    ds_read_b128 v[100:103], v3 offset:22528
    v_exp_f32 v36, v36
    v_exp_f32 v37, v37
    v_exp_f32 v38, v38
    v_exp_f32 v39, v39
    v_exp_f32 v40, v40
    v_exp_f32 v41, v41
    s_waitcnt lgkmcnt(4)
    v_smfmac_f32_32x32x32_bf16 v[80:95], v[112:115], v[32:39], v5
    v_exp_f32 v42, v42
    v_exp_f32 v43, v43
    v_exp_f32 v44, v44
    v_exp_f32 v45, v45
    v_exp_f32 v46, v46
    v_exp_f32 v47, v47
    v_exp_f32 v48, v48
    v_exp_f32 v49, v49
    v_smfmac_f32_32x32x32_bf16 v[80:95], v[116:119], v[40:47], v5
    v_exp_f32 v50, v50
    v_exp_f32 v51, v51
    s_waitcnt lgkmcnt(3)
    v_mfma_f32_32x32x16_bf16 v[32:47], v[96:99], v[124:127], v[16:31]
    v_exp_f32 v52, v52
    v_exp_f32 v53, v53
    v_exp_f32 v54, v54
    s_lshl_b32 s73, s3, 3
    s_add_u32 s73, s73, s68
    s_lshl_b32 s73, s73, 1
    s_add_u32 s73, s73, s83
    s_lshl_b32 s73, s73, 4
    s_add_u32 s73, s73, s87
    s_lshl_b32 s73, s73, 2
    s_add_u32 s73, s73, 0xc1a000
    s_waitcnt vmcnt(8)
    v_mov_b32 v9, 1
    s_mov_b64 exec, 1
    s_cmp_lg_u32 s6, 0
    s_cbranch_scc1 Lfs34
    buffer_store_dword v9, off, s[40:43], s73 sc1
    s_branch Lfj35
Lfs34:
    buffer_store_dword v9, off, s[40:43], s73
Lfj35:
    s_mov_b64 exec, -1
    s_cmp_lt_u32 s68, 4
    s_cbranch_scc1 Lcn36
    s_setprio 0
Lcn36:
    v_exp_f32 v55, v55
    v_exp_f32 v56, v56
    v_exp_f32 v57, v57
    v_smfmac_f32_32x32x32_bf16 v[64:79], v[112:115], v[48:55], v5
    v_exp_f32 v58, v58
    v_exp_f32 v59, v59
    v_exp_f32 v60, v60
    v_exp_f32 v61, v61
    v_exp_f32 v62, v62
    v_exp_f32 v63, v63
    v_exp_f32 v32, v32
    v_exp_f32 v33, v33
    v_smfmac_f32_32x32x32_bf16 v[64:79], v[116:119], v[56:63], v5
    s_mov_b64 exec, s[0:1]
    ds_read_b128 v[112:115], v4 offset:23552
    ds_read_b128 v[116:119], v4 offset:24064
    s_mov_b64 exec, -1
    v_exp_f32 v34, v34
    v_exp_f32 v35, v35
    v_mfma_f32_32x32x16_bf16 v[48:63], v[96:99], v[120:123], v[16:31]
    ds_read_b128 v[96:99], v3 offset:24576
    v_exp_f32 v36, v36
    v_exp_f32 v37, v37
    v_exp_f32 v38, v38
    s_cmp_lt_u32 s68, 4
    s_cbranch_scc1 Lcn37
    s_setprio 1
Lcn37:
    v_exp_f32 v39, v39
    v_exp_f32 v40, v40
    v_exp_f32 v41, v41
    s_waitcnt lgkmcnt(4)
    v_smfmac_f32_32x32x32_bf16 v[80:95], v[104:107], v[32:39], v5
    v_exp_f32 v42, v42
    v_exp_f32 v43, v43
    v_exp_f32 v44, v44
    v_exp_f32 v45, v45
    v_exp_f32 v46, v46
    v_exp_f32 v47, v47
    v_exp_f32 v48, v48
    v_exp_f32 v49, v49
    v_smfmac_f32_32x32x32_bf16 v[80:95], v[108:111], v[40:47], v5
    v_exp_f32 v50, v50
    v_exp_f32 v51, v51
    s_waitcnt lgkmcnt(3)
    v_mfma_f32_32x32x16_bf16 v[32:47], v[100:103], v[124:127], v[16:31]
    v_exp_f32 v52, v52
    v_exp_f32 v53, v53
    v_exp_f32 v54, v54
    v_exp_f32 v55, v55
    v_exp_f32 v56, v56
    v_exp_f32 v57, v57
    v_smfmac_f32_32x32x32_bf16 v[64:79], v[104:107], v[48:55], v5
    v_exp_f32 v58, v58
    v_exp_f32 v59, v59
    v_exp_f32 v60, v60
    v_exp_f32 v61, v61
    v_exp_f32 v62, v62
    v_exp_f32 v63, v63
    v_exp_f32 v32, v32
    v_exp_f32 v33, v33
    v_smfmac_f32_32x32x32_bf16 v[64:79], v[108:111], v[56:63], v5
    s_mov_b64 exec, s[0:1]
    ds_read_b128 v[104:107], v4 offset:25600
    ds_read_b128 v[108:111], v4 offset:26112
    s_mov_b64 exec, -1
    v_exp_f32 v34, v34
    v_exp_f32 v35, v35
    v_mfma_f32_32x32x16_bf16 v[48:63], v[100:103], v[120:123], v[16:31]
    ds_read_b128 v[100:103], v3 offset:26624
    v_exp_f32 v36, v36
    v_exp_f32 v37, v37
    v_exp_f32 v38, v38
    v_exp_f32 v39, v39
    v_exp_f32 v40, v40
    v_exp_f32 v41, v41
    s_waitcnt lgkmcnt(4)
    v_smfmac_f32_32x32x32_bf16 v[80:95], v[112:115], v[32:39], v5
    v_exp_f32 v42, v42
    v_exp_f32 v43, v43
    v_exp_f32 v44, v44
    v_exp_f32 v45, v45
    v_exp_f32 v46, v46
    v_exp_f32 v47, v47
    v_exp_f32 v48, v48
    v_exp_f32 v49, v49
    v_smfmac_f32_32x32x32_bf16 v[80:95], v[116:119], v[40:47], v5
    v_exp_f32 v50, v50
    v_exp_f32 v51, v51
    s_waitcnt lgkmcnt(3)
    v_mfma_f32_32x32x16_bf16 v[32:47], v[96:99], v[124:127], v[16:31]
    v_exp_f32 v52, v52
    v_exp_f32 v53, v53
    v_exp_f32 v54, v54
    s_and_b32 s72, s88, 3
    s_lshl_b32 s73, s72, 1
    s_lshr_b32 s74, s68, 2
    s_add_u32 s73, s73, s74
    s_lshl_b32 s73, s73, 7
    v_lshl_add_u32 v10, v1, 2, s73
    s_lshr_b32 s72, s72, 1
    s_lshl_b32 s72, s72, 2
    s_and_b32 s73, s90, 3
    s_add_u32 s72, s72, s73
    s_lshl_b32 s72, s72, 5
    s_lshr_b32 s73, s90, 2
    s_add_u32 s72, s72, s73
    s_lshl_b32 s72, s72, 2
    s_add_u32 s72, s72, 64
    s_mov_b64 exec, 0xffff
    s_not_b64 exec, exec
    v_mov_b32 v10, s72
    s_mov_b64 exec, -1
    s_lshl_b32 s8, s69, 10
    s_add_u32 s8, s8, 0xc1a000
    buffer_load_dword v14, v10, s[40:43], s8 offen sc1
    s_cmp_lt_u32 s68, 4
    s_cbranch_scc1 Lcn38
    s_setprio 0
Lcn38:
    v_exp_f32 v55, v55
    v_exp_f32 v56, v56
    v_exp_f32 v57, v57
    v_smfmac_f32_32x32x32_bf16 v[64:79], v[112:115], v[48:55], v5
    v_exp_f32 v58, v58
    v_exp_f32 v59, v59
    v_exp_f32 v60, v60
    v_exp_f32 v61, v61
    v_exp_f32 v62, v62
    v_exp_f32 v63, v63
    v_exp_f32 v32, v32
    v_exp_f32 v33, v33
    v_smfmac_f32_32x32x32_bf16 v[64:79], v[116:119], v[56:63], v5
    s_mov_b64 exec, s[0:1]
    ds_read_b128 v[112:115], v4 offset:27648
    ds_read_b128 v[116:119], v4 offset:28160
    s_mov_b64 exec, -1
    v_exp_f32 v34, v34
    v_exp_f32 v35, v35
    v_mfma_f32_32x32x16_bf16 v[48:63], v[96:99], v[120:123], v[16:31]
    ds_read_b128 v[96:99], v3 offset:28672
    v_exp_f32 v36, v36
    v_exp_f32 v37, v37
    v_exp_f32 v38, v38
    s_cmp_lt_u32 s68, 4
    s_cbranch_scc1 Lcn39
    s_setprio 1
Lcn39:
    v_exp_f32 v39, v39
    v_exp_f32 v40, v40
    v_exp_f32 v41, v41
    s_waitcnt lgkmcnt(4)
    v_smfmac_f32_32x32x32_bf16 v[80:95], v[104:107], v[32:39], v5
    v_exp_f32 v42, v42
    v_exp_f32 v43, v43
    v_exp_f32 v44, v44
    v_exp_f32 v45, v45
    v_exp_f32 v46, v46
    v_exp_f32 v47, v47
    v_exp_f32 v48, v48
    v_exp_f32 v49, v49
    v_smfmac_f32_32x32x32_bf16 v[80:95], v[108:111], v[40:47], v5
    v_exp_f32 v50, v50
    v_exp_f32 v51, v51
    s_waitcnt lgkmcnt(3)
    v_mfma_f32_32x32x16_bf16 v[32:47], v[100:103], v[124:127], v[16:31]
    v_exp_f32 v52, v52
    v_exp_f32 v53, v53
    v_exp_f32 v54, v54
    s_waitcnt vmcnt(0)
    s_mov_b32 s91, 0
Lsp40:
    v_cmp_eq_u32 vcc, 0, v14
    s_nop 0
    s_cbranch_vccz Lsd41
    s_sleep 4
    buffer_load_dword v14, v10, s[40:43], s8 offen sc1
    s_add_u32 s91, s91, 1
    s_cmp_lt_u32 s91, 400000
    s_waitcnt vmcnt(0)
    s_cbranch_scc1 Lsp40
Lsd41:
    buffer_load_dwordx4 v[192:195], v2, s[40:43], s94 offen offset:0 sc1
    v_exp_f32 v55, v55
    v_exp_f32 v56, v56
    v_exp_f32 v57, v57
    v_smfmac_f32_32x32x32_bf16 v[64:79], v[104:107], v[48:55], v5
    v_exp_f32 v58, v58
    v_exp_f32 v59, v59
    v_exp_f32 v60, v60
    v_exp_f32 v61, v61
    v_exp_f32 v62, v62
    v_exp_f32 v63, v63
    v_exp_f32 v32, v32
    v_exp_f32 v33, v33
    v_smfmac_f32_32x32x32_bf16 v[64:79], v[108:111], v[56:63], v5
    s_mov_b64 exec, s[0:1]
    ds_read_b128 v[104:107], v4 offset:29696
    ds_read_b128 v[108:111], v4 offset:30208
    s_mov_b64 exec, -1
    v_exp_f32 v34, v34
    v_exp_f32 v35, v35
    v_mfma_f32_32x32x16_bf16 v[48:63], v[100:103], v[120:123], v[16:31]
    ds_read_b128 v[100:103], v3 offset:30720
    v_exp_f32 v36, v36
    v_exp_f32 v37, v37
    v_exp_f32 v38, v38
    s_barrier
    buffer_load_dwordx4 v[196:199], v2, s[40:43], s94 offen offset:1024 sc1
    v_exp_f32 v39, v39
    v_exp_f32 v40, v40
    v_exp_f32 v41, v41
    s_waitcnt lgkmcnt(4)
    v_smfmac_f32_32x32x32_bf16 v[80:95], v[112:115], v[32:39], v5
    v_exp_f32 v42, v42
    v_exp_f32 v43, v43
    v_exp_f32 v44, v44
    v_exp_f32 v45, v45
    v_exp_f32 v46, v46
    v_exp_f32 v47, v47
    v_exp_f32 v48, v48
    v_exp_f32 v49, v49
    v_smfmac_f32_32x32x32_bf16 v[80:95], v[116:119], v[40:47], v5
    v_exp_f32 v50, v50
    v_exp_f32 v51, v51
    s_waitcnt lgkmcnt(3)
    v_mfma_f32_32x32x16_bf16 v[32:47], v[96:99], v[124:127], v[16:31]
    v_exp_f32 v52, v52
    v_exp_f32 v53, v53
    v_exp_f32 v54, v54
    s_lshl_b32 s86, s11, 13
    s_add_u32 s86, s86, s92
    s_add_u32 m0, s86, 0
    s_add_u32 s72, s93, 0
    buffer_load_dwordx4 v6, s[56:59], s72 offen lds
    buffer_load_dwordx4 v[200:203], v2, s[40:43], s94 offen offset:2048 sc1
    s_cmp_lt_u32 s68, 4
    s_cbranch_scc1 Lcn42
    s_setprio 0
Lcn42:
    v_exp_f32 v55, v55
    v_exp_f32 v56, v56
    v_exp_f32 v57, v57
    v_smfmac_f32_32x32x32_bf16 v[64:79], v[112:115], v[48:55], v5
    v_exp_f32 v58, v58
    v_exp_f32 v59, v59
    v_exp_f32 v60, v60
    v_exp_f32 v61, v61
    v_exp_f32 v62, v62
    v_exp_f32 v63, v63
    v_exp_f32 v32, v32
    v_exp_f32 v33, v33
    v_smfmac_f32_32x32x32_bf16 v[64:79], v[116:119], v[56:63], v5
    s_mov_b64 exec, s[0:1]
    ds_read_b128 v[112:115], v4 offset:31744
    ds_read_b128 v[116:119], v4 offset:32256
    s_mov_b64 exec, -1
    v_exp_f32 v34, v34
    v_exp_f32 v35, v35
    v_mfma_f32_32x32x16_bf16 v[48:63], v[96:99], v[120:123], v[16:31]
    ds_read_b128 v[96:99], v3 offset:32768
    v_exp_f32 v36, v36
    v_exp_f32 v37, v37
    v_exp_f32 v38, v38
    s_add_u32 m0, s86, 1024
    s_add_u32 s72, s93, 8192
    buffer_load_dwordx4 v6, s[56:59], s72 offen lds
    buffer_load_dwordx4 v[204:207], v2, s[40:43], s94 offen offset:3072 sc1
    s_cmp_lt_u32 s68, 4
    s_cbranch_scc1 Lcn43
    s_setprio 1
Lcn43:
    v_exp_f32 v39, v39
    v_exp_f32 v40, v40
    v_exp_f32 v41, v41
    s_waitcnt lgkmcnt(4)
    v_smfmac_f32_32x32x32_bf16 v[80:95], v[104:107], v[32:39], v5
    v_exp_f32 v42, v42
    v_exp_f32 v43, v43
    v_exp_f32 v44, v44
    v_exp_f32 v45, v45
    v_exp_f32 v46, v46
    v_exp_f32 v47, v47
    v_exp_f32 v48, v48
    v_exp_f32 v49, v49
    v_smfmac_f32_32x32x32_bf16 v[80:95], v[108:111], v[40:47], v5
    v_exp_f32 v50, v50
    v_exp_f32 v51, v51
    s_waitcnt lgkmcnt(3)
    v_mfma_f32_32x32x16_bf16 v[32:47], v[100:103], v[124:127], v[16:31]
    v_exp_f32 v52, v52
    v_exp_f32 v53, v53
    v_exp_f32 v54, v54
    s_add_u32 m0, s86, 2048
    s_add_u32 s72, s93, 16384
    buffer_load_dwordx4 v6, s[56:59], s72 offen lds
    s_add_u32 s94, s94, 4096
    buffer_load_dwordx4 v[208:211], v2, s[40:43], s94 offen offset:0 sc1
    v_exp_f32 v55, v55
    v_exp_f32 v56, v56
    v_exp_f32 v57, v57
    v_smfmac_f32_32x32x32_bf16 v[64:79], v[104:107], v[48:55], v5
    v_exp_f32 v58, v58
    v_exp_f32 v59, v59
    v_exp_f32 v60, v60
    v_exp_f32 v61, v61
    v_exp_f32 v62, v62
    v_exp_f32 v63, v63
    v_exp_f32 v32, v32
    v_exp_f32 v33, v33
    v_smfmac_f32_32x32x32_bf16 v[64:79], v[108:111], v[56:63], v5
    s_mov_b64 exec, s[0:1]
    ds_read_b128 v[104:107], v4 offset:33792
    ds_read_b128 v[108:111], v4 offset:34304
    s_mov_b64 exec, -1
    v_exp_f32 v34, v34
    v_exp_f32 v35, v35
    v_mfma_f32_32x32x16_bf16 v[48:63], v[100:103], v[120:123], v[16:31]
    ds_read_b128 v[100:103], v3 offset:34816
    v_exp_f32 v36, v36
    v_exp_f32 v37, v37
    v_exp_f32 v38, v38
    s_add_u32 m0, s86, 3072
    s_add_u32 s72, s93, 24576
    buffer_load_dwordx4 v6, s[56:59], s72 offen lds
    buffer_load_dwordx4 v[212:215], v2, s[40:43], s94 offen offset:1024 sc1
    v_exp_f32 v39, v39
    v_exp_f32 v40, v40
    v_exp_f32 v41, v41
    s_waitcnt lgkmcnt(4)
    v_smfmac_f32_32x32x32_bf16 v[80:95], v[112:115], v[32:39], v5
    v_exp_f32 v42, v42
    v_exp_f32 v43, v43
    v_exp_f32 v44, v44
    v_exp_f32 v45, v45
    v_exp_f32 v46, v46
    v_exp_f32 v47, v47
    v_exp_f32 v48, v48
    v_exp_f32 v49, v49
    v_smfmac_f32_32x32x32_bf16 v[80:95], v[116:119], v[40:47], v5
    v_exp_f32 v50, v50
    v_exp_f32 v51, v51
    s_waitcnt lgkmcnt(3)
    v_mfma_f32_32x32x16_bf16 v[32:47], v[96:99], v[124:127], v[16:31]
    v_exp_f32 v52, v52
    v_exp_f32 v53, v53
    v_exp_f32 v54, v54
    s_add_u32 m0, s86, 4096
    s_add_u32 s72, s93, 32768
    buffer_load_dwordx4 v6, s[56:59], s72 offen lds
    buffer_load_dwordx4 v[216:219], v2, s[40:43], s94 offen offset:2048 sc1
    s_cmp_lt_u32 s68, 4
    s_cbranch_scc1 Lcn44
    s_setprio 0
Lcn44:
    v_exp_f32 v55, v55
    v_exp_f32 v56, v56
    v_exp_f32 v57, v57
    v_smfmac_f32_32x32x32_bf16 v[64:79], v[112:115], v[48:55], v5
    v_exp_f32 v58, v58
    v_exp_f32 v59, v59
    v_exp_f32 v60, v60
    v_exp_f32 v61, v61
    v_exp_f32 v62, v62
    v_exp_f32 v63, v63
    v_exp_f32 v32, v32
    v_exp_f32 v33, v33
    v_smfmac_f32_32x32x32_bf16 v[64:79], v[116:119], v[56:63], v5
    s_mov_b64 exec, s[0:1]
    ds_read_b128 v[112:115], v4 offset:35840
    ds_read_b128 v[116:119], v4 offset:36352
    s_mov_b64 exec, -1
    v_exp_f32 v34, v34
    v_exp_f32 v35, v35
    v_mfma_f32_32x32x16_bf16 v[48:63], v[96:99], v[120:123], v[16:31]
    ds_read_b128 v[96:99], v3 offset:36864
    v_exp_f32 v36, v36
    v_exp_f32 v37, v37
    v_exp_f32 v38, v38
    s_add_u32 m0, s86, 5120
    s_add_u32 s72, s93, 40960
    buffer_load_dwordx4 v6, s[56:59], s72 offen lds
    buffer_load_dwordx4 v[220:223], v2, s[40:43], s94 offen offset:3072 sc1
    s_cmp_lt_u32 s68, 4
    s_cbranch_scc1 Lcn45
    s_setprio 1
Lcn45:
    v_exp_f32 v39, v39
    v_exp_f32 v40, v40
    v_exp_f32 v41, v41
    s_waitcnt lgkmcnt(4)
    v_smfmac_f32_32x32x32_bf16 v[80:95], v[104:107], v[32:39], v5
    v_exp_f32 v42, v42
    v_exp_f32 v43, v43
    v_exp_f32 v44, v44
    v_exp_f32 v45, v45
    v_exp_f32 v46, v46
    v_exp_f32 v47, v47
    v_exp_f32 v48, v48
    v_exp_f32 v49, v49
    v_smfmac_f32_32x32x32_bf16 v[80:95], v[108:111], v[40:47], v5
    v_exp_f32 v50, v50
    v_exp_f32 v51, v51
    s_waitcnt lgkmcnt(3)
    v_mfma_f32_32x32x16_bf16 v[32:47], v[100:103], v[124:127], v[16:31]
    v_exp_f32 v52, v52
    v_exp_f32 v53, v53
    v_exp_f32 v54, v54
    s_add_u32 m0, s86, 6144
    s_add_u32 s72, s93, 49152
    buffer_load_dwordx4 v6, s[56:59], s72 offen lds
    s_lshl_b32 s72, s88, 17
    s_lshl_b32 s73, s90, 11
    s_add_u32 s72, s72, s73
    s_add_u32 s72, s72, 0x600000
    buffer_load_dwordx4 v[228:231], v2, s[40:43], s72 offen sc1
    buffer_load_dwordx4 v[232:235], v2, s[40:43], s72 offen offset:1024 sc1
    v_exp_f32 v55, v55
    v_exp_f32 v56, v56
    v_exp_f32 v57, v57
    v_smfmac_f32_32x32x32_bf16 v[64:79], v[104:107], v[48:55], v5
    v_exp_f32 v58, v58
    v_exp_f32 v59, v59
    v_exp_f32 v60, v60
    v_exp_f32 v61, v61
    v_exp_f32 v62, v62
    v_exp_f32 v63, v63
    v_exp_f32 v32, v32
    v_exp_f32 v33, v33
    v_smfmac_f32_32x32x32_bf16 v[64:79], v[108:111], v[56:63], v5
    s_mov_b64 exec, s[0:1]
    ds_read_b128 v[104:107], v4 offset:37888
    ds_read_b128 v[108:111], v4 offset:38400
    s_mov_b64 exec, -1
    v_exp_f32 v34, v34
    v_exp_f32 v35, v35
    v_mfma_f32_32x32x16_bf16 v[48:63], v[100:103], v[120:123], v[16:31]
    ds_read_b128 v[100:103], v3 offset:38912
    v_exp_f32 v36, v36
    v_exp_f32 v37, v37
    v_exp_f32 v38, v38
    s_add_u32 m0, s86, 7168
    s_add_u32 s72, s93, 57344
    buffer_load_dwordx4 v6, s[56:59], s72 offen lds
    v_exp_f32 v39, v39
    v_exp_f32 v40, v40
    v_exp_f32 v41, v41
    s_waitcnt lgkmcnt(4)
    v_smfmac_f32_32x32x32_bf16 v[80:95], v[112:115], v[32:39], v5
    v_exp_f32 v42, v42
    v_exp_f32 v43, v43
    v_exp_f32 v44, v44
    v_exp_f32 v45, v45
    v_exp_f32 v46, v46
    v_exp_f32 v47, v47
    v_exp_f32 v48, v48
    v_exp_f32 v49, v49
    v_smfmac_f32_32x32x32_bf16 v[80:95], v[116:119], v[40:47], v5
    v_exp_f32 v50, v50
    v_exp_f32 v51, v51
    s_waitcnt lgkmcnt(3)
    v_mfma_f32_32x32x16_bf16 v[32:47], v[96:99], v[124:127], v[16:31]
    v_exp_f32 v52, v52
    v_exp_f32 v53, v53
    v_exp_f32 v54, v54
    s_cmp_lt_u32 s68, 4
    s_cbranch_scc1 Lcn46
    s_setprio 0
Lcn46:
    v_exp_f32 v55, v55
    v_exp_f32 v56, v56
    v_exp_f32 v57, v57
    v_smfmac_f32_32x32x32_bf16 v[64:79], v[112:115], v[48:55], v5
    v_exp_f32 v58, v58
    v_exp_f32 v59, v59
    v_exp_f32 v60, v60
    v_exp_f32 v61, v61
    v_exp_f32 v62, v62
    v_exp_f32 v63, v63
    v_exp_f32 v32, v32
    v_exp_f32 v33, v33
    v_smfmac_f32_32x32x32_bf16 v[64:79], v[116:119], v[56:63], v5
    s_mov_b64 exec, s[0:1]
    ds_read_b128 v[112:115], v4 offset:39936
    ds_read_b128 v[116:119], v4 offset:40448
    s_mov_b64 exec, -1
    v_exp_f32 v34, v34
    v_exp_f32 v35, v35
    v_mfma_f32_32x32x16_bf16 v[48:63], v[96:99], v[120:123], v[16:31]
    ds_read_b128 v[96:99], v3 offset:40960
    v_exp_f32 v36, v36
    v_exp_f32 v37, v37
    v_exp_f32 v38, v38
    s_waitcnt vmcnt(4)
    v_add_f32 v192, v192, v208
    v_add_f32 v193, v193, v209
    v_add_f32 v194, v194, v210
    v_add_f32 v195, v195, v211
    v_add_f32 v196, v196, v212
    v_add_f32 v197, v197, v213
    v_add_f32 v198, v198, v214
    v_add_f32 v199, v199, v215
    v_add_f32 v200, v200, v216
    v_add_f32 v201, v201, v217
    v_add_f32 v202, v202, v218
    v_add_f32 v203, v203, v219
    v_add_f32 v204, v204, v220
    v_add_f32 v205, v205, v221
    v_add_f32 v206, v206, v222
    v_add_f32 v207, v207, v223
    v_add_f32 v192, v192, v200
    v_add_f32 v193, v193, v201
    v_add_f32 v194, v194, v202
    v_add_f32 v195, v195, v203
    v_add_f32 v196, v196, v204
    v_add_f32 v197, v197, v205
    v_add_f32 v198, v198, v206
    v_add_f32 v199, v199, v207
    v_add_f32 v192, v192, v196
    v_add_f32 v193, v193, v197
    v_add_f32 v194, v194, v198
    v_add_f32 v195, v195, v199
    v_and_b32 v9, 31, v1
    v_lshrrev_b32 v10, 5, v1
    v_permlane32_swap_b32 v192, v194
    v_permlane32_swap_b32 v193, v195
    v_lshl_add_u32 v9, v9, 1, v10
    s_lshr_b32 s72, s68, 2
    s_lshl_b32 s72, s72, 10
    s_lshl_b32 s73, s95, 2
    s_add_u32 s72, s72, s73
    v_add_f32 v192, v192, v194
    v_add_f32 v193, v193, v195
    v_lshl_add_u32 v9, v9, 4, s72
    v_cvt_pk_bf16_f32 v200, v192, v193
    ds_write_b32 v9, v200
    s_cmp_lt_u32 s68, 4
    s_cbranch_scc1 Lcn47
    s_setprio 1
Lcn47:
    v_exp_f32 v39, v39
    v_exp_f32 v40, v40
    v_exp_f32 v41, v41
    s_waitcnt lgkmcnt(5)
    v_smfmac_f32_32x32x32_bf16 v[80:95], v[104:107], v[32:39], v5
    v_exp_f32 v42, v42
    v_exp_f32 v43, v43
    v_exp_f32 v44, v44
    v_exp_f32 v45, v45
    v_exp_f32 v46, v46
    v_exp_f32 v47, v47
    v_exp_f32 v48, v48
    v_exp_f32 v49, v49
    v_smfmac_f32_32x32x32_bf16 v[80:95], v[108:111], v[40:47], v5
    v_exp_f32 v50, v50
    v_exp_f32 v51, v51
    s_waitcnt lgkmcnt(4)
    v_mfma_f32_32x32x16_bf16 v[32:47], v[100:103], v[124:127], v[16:31]
    v_exp_f32 v52, v52
    v_exp_f32 v53, v53
    v_exp_f32 v54, v54
    s_waitcnt vmcnt(0)
    s_waitcnt lgkmcnt(0)
    s_barrier
    ds_read_b128 v[192:195], v2
    ds_read_b128 v[196:199], v2 offset:1024
    ds_read_b64_tr_b16 v[128:129], v7 offset:0
    ds_read_b64_tr_b16 v[130:131], v7 offset:1024
    ds_read_b64_tr_b16 v[132:133], v8 offset:0
    ds_read_b64_tr_b16 v[134:135], v8 offset:1024
    v_exp_f32 v55, v55
    v_exp_f32 v56, v56
    v_exp_f32 v57, v57
    v_smfmac_f32_32x32x32_bf16 v[64:79], v[104:107], v[48:55], v5
    v_exp_f32 v58, v58
    v_exp_f32 v59, v59
    v_exp_f32 v60, v60
    v_exp_f32 v61, v61
    v_exp_f32 v62, v62
    v_exp_f32 v63, v63
    v_exp_f32 v32, v32
    v_exp_f32 v33, v33
    v_smfmac_f32_32x32x32_bf16 v[64:79], v[108:111], v[56:63], v5
    s_mov_b64 exec, s[0:1]
    ds_read_b128 v[104:107], v4 offset:41984
    ds_read_b128 v[108:111], v4 offset:42496
    s_mov_b64 exec, -1
    v_exp_f32 v34, v34
    v_exp_f32 v35, v35
    v_mfma_f32_32x32x16_bf16 v[48:63], v[100:103], v[120:123], v[16:31]
    ds_read_b128 v[100:103], v3 offset:43008
    v_exp_f32 v36, v36
    v_exp_f32 v37, v37
    v_exp_f32 v38, v38
    ds_read_b64_tr_b16 v[136:137], v7 offset:2048
    ds_read_b64_tr_b16 v[138:139], v7 offset:3072
    ds_read_b64_tr_b16 v[140:141], v8 offset:2048
    ds_read_b64_tr_b16 v[142:143], v8 offset:3072
    s_waitcnt lgkmcnt(11)
    v_mfma_f32_32x32x16_bf16 v[236:251], v[192:195], v[228:231], 0
    v_mfma_f32_32x32x16_bf16 v[236:251], v[196:199], v[232:235], v[236:251]
    v_exp_f32 v39, v39
    v_exp_f32 v40, v40
    v_exp_f32 v41, v41
    v_smfmac_f32_32x32x32_bf16 v[80:95], v[112:115], v[32:39], v5
    v_exp_f32 v42, v42
    v_exp_f32 v43, v43
    v_exp_f32 v44, v44
    v_exp_f32 v45, v45
    v_exp_f32 v46, v46
    v_exp_f32 v47, v47
    v_exp_f32 v48, v48
    v_exp_f32 v49, v49
    v_smfmac_f32_32x32x32_bf16 v[80:95], v[116:119], v[40:47], v5
    v_exp_f32 v50, v50
    v_exp_f32 v51, v51
    v_mfma_f32_32x32x16_bf16 v[32:47], v[96:99], v[124:127], v[16:31]
    v_exp_f32 v52, v52
    v_exp_f32 v53, v53
    v_exp_f32 v54, v54
    ds_read_b64_tr_b16 v[144:145], v7 offset:4096
    ds_read_b64_tr_b16 v[146:147], v7 offset:5120
    ds_read_b64_tr_b16 v[148:149], v8 offset:4096
    ds_read_b64_tr_b16 v[150:151], v8 offset:5120
    v_add_f32 v9, 0x358637bd, v244
    v_rcp_f32 v9, v9
    s_lshl_b32 s72, s90, 11
    s_nop 0
    v_mul_f32 v236, v9, v236
    v_mul_f32 v237, v9, v237
    v_mul_f32 v238, v9, v238
    v_mul_f32 v239, v9, v239
    v_mul_f32 v240, v9, v240
    v_mul_f32 v241, v9, v241
    v_mul_f32 v242, v9, v242
    v_mul_f32 v243, v9, v243
    v_cvt_pk_bf16_f32 v236, v236, v237
    v_cvt_pk_bf16_f32 v237, v238, v239
    v_cvt_pk_bf16_f32 v238, v240, v241
    v_cvt_pk_bf16_f32 v239, v242, v243
    s_lshl_b32 s73, s88, 17
    s_add_u32 s73, s72, s73
    s_add_u32 s72, s73, 0x600000
    s_lshr_b32 s73, s73, 1
    buffer_store_dwordx4 v[236:239], v2, s[40:43], s72 offen sc1
    v_mov_b64 v[240:241], -1
    v_mov_b64 v[242:243], -1
    s_add_u32 s101, s73, 0x400000
    buffer_store_dwordx4 v[240:243], v2, s[40:43], s101 offen sc1
    s_cmp_lt_u32 s68, 4
    s_cbranch_scc1 Lcn48
    s_setprio 0
Lcn48:
    v_exp_f32 v55, v55
    v_exp_f32 v56, v56
    v_exp_f32 v57, v57
    v_smfmac_f32_32x32x32_bf16 v[64:79], v[112:115], v[48:55], v5
    v_exp_f32 v58, v58
    v_exp_f32 v59, v59
    v_exp_f32 v60, v60
    v_exp_f32 v61, v61
    v_exp_f32 v62, v62
    v_exp_f32 v63, v63
    v_exp_f32 v32, v32
    v_exp_f32 v33, v33
    v_smfmac_f32_32x32x32_bf16 v[64:79], v[116:119], v[56:63], v5
    s_mov_b64 exec, s[0:1]
    ds_read_b128 v[112:115], v4 offset:44032
    ds_read_b128 v[116:119], v4 offset:44544
    s_mov_b64 exec, -1
    v_exp_f32 v34, v34
    v_exp_f32 v35, v35
    v_mfma_f32_32x32x16_bf16 v[48:63], v[96:99], v[120:123], v[16:31]
    ds_read_b128 v[96:99], v3 offset:45056
    v_exp_f32 v36, v36
    v_exp_f32 v37, v37
    v_exp_f32 v38, v38
    ds_read_b64_tr_b16 v[152:153], v7 offset:6144
    ds_read_b64_tr_b16 v[154:155], v7 offset:7168
    ds_read_b64_tr_b16 v[156:157], v8 offset:6144
    ds_read_b64_tr_b16 v[158:159], v8 offset:7168
    s_cmp_lt_u32 s68, 4
    s_cbranch_scc1 Lcn49
    s_setprio 1
Lcn49:
    v_exp_f32 v39, v39
    v_exp_f32 v40, v40
    v_exp_f32 v41, v41
    s_waitcnt lgkmcnt(15)
    v_smfmac_f32_32x32x32_bf16 v[80:95], v[104:107], v[32:39], v5
    v_exp_f32 v42, v42
    v_exp_f32 v43, v43
    v_exp_f32 v44, v44
    v_exp_f32 v45, v45
    v_exp_f32 v46, v46
    v_exp_f32 v47, v47
    v_exp_f32 v48, v48
    v_exp_f32 v49, v49
    v_smfmac_f32_32x32x32_bf16 v[80:95], v[108:111], v[40:47], v5
    v_exp_f32 v50, v50
    v_exp_f32 v51, v51
    v_mfma_f32_32x32x16_bf16 v[32:47], v[100:103], v[124:127], v[16:31]
    v_exp_f32 v52, v52
    v_exp_f32 v53, v53
    v_exp_f32 v54, v54
    ds_read_b64_tr_b16 v[160:161], v7 offset:8192
    ds_read_b64_tr_b16 v[162:163], v7 offset:9216
    ds_read_b64_tr_b16 v[164:165], v8 offset:8192
    ds_read_b64_tr_b16 v[166:167], v8 offset:9216
    v_exp_f32 v55, v55
    v_exp_f32 v56, v56
    v_exp_f32 v57, v57
    v_smfmac_f32_32x32x32_bf16 v[64:79], v[104:107], v[48:55], v5
    v_exp_f32 v58, v58
    v_exp_f32 v59, v59
    v_exp_f32 v60, v60
    v_exp_f32 v61, v61
    v_exp_f32 v62, v62
    v_exp_f32 v63, v63
    v_exp_f32 v32, v32
    v_exp_f32 v33, v33
    v_smfmac_f32_32x32x32_bf16 v[64:79], v[108:111], v[56:63], v5
    s_mov_b64 exec, s[0:1]
    ds_read_b128 v[104:107], v4 offset:46080
    ds_read_b128 v[108:111], v4 offset:46592
    s_mov_b64 exec, -1
    v_exp_f32 v34, v34
    v_exp_f32 v35, v35
    v_mfma_f32_32x32x16_bf16 v[48:63], v[100:103], v[120:123], v[16:31]
    ds_read_b128 v[100:103], v3 offset:47104
    v_exp_f32 v36, v36
    v_exp_f32 v37, v37
    v_exp_f32 v38, v38
    ds_read_b64_tr_b16 v[168:169], v7 offset:10240
    ds_read_b64_tr_b16 v[170:171], v7 offset:11264
    ds_read_b64_tr_b16 v[172:173], v8 offset:10240
    ds_read_b64_tr_b16 v[174:175], v8 offset:11264
    v_exp_f32 v39, v39
    v_exp_f32 v40, v40
    v_exp_f32 v41, v41
    s_waitcnt lgkmcnt(15)
    v_smfmac_f32_32x32x32_bf16 v[80:95], v[112:115], v[32:39], v5
    v_exp_f32 v42, v42
    v_exp_f32 v43, v43
    v_exp_f32 v44, v44
    v_exp_f32 v45, v45
    v_exp_f32 v46, v46
    v_exp_f32 v47, v47
    v_exp_f32 v48, v48
    v_exp_f32 v49, v49
    v_smfmac_f32_32x32x32_bf16 v[80:95], v[116:119], v[40:47], v5
    v_exp_f32 v50, v50
    v_exp_f32 v51, v51
    v_mfma_f32_32x32x16_bf16 v[32:47], v[96:99], v[124:127], v[16:31]
    v_exp_f32 v52, v52
    v_exp_f32 v53, v53
    v_exp_f32 v54, v54
    ds_read_b64_tr_b16 v[176:177], v7 offset:12288
    ds_read_b64_tr_b16 v[178:179], v7 offset:13312
    ds_read_b64_tr_b16 v[180:181], v8 offset:12288
    ds_read_b64_tr_b16 v[182:183], v8 offset:13312
    s_cmp_lt_u32 s68, 4
    s_cbranch_scc1 Lcn50
    s_setprio 0
Lcn50:
    v_exp_f32 v55, v55
    v_exp_f32 v56, v56
    v_exp_f32 v57, v57
    v_smfmac_f32_32x32x32_bf16 v[64:79], v[112:115], v[48:55], v5
    v_exp_f32 v58, v58
    v_exp_f32 v59, v59
    v_exp_f32 v60, v60
    v_exp_f32 v61, v61
    v_exp_f32 v62, v62
    v_exp_f32 v63, v63
    v_exp_f32 v32, v32
    v_exp_f32 v33, v33
    v_smfmac_f32_32x32x32_bf16 v[64:79], v[116:119], v[56:63], v5
    s_mov_b64 exec, s[0:1]
    ds_read_b128 v[112:115], v4 offset:48128
    ds_read_b128 v[116:119], v4 offset:48640
    s_mov_b64 exec, -1
    v_exp_f32 v34, v34
    v_exp_f32 v35, v35
    v_mfma_f32_32x32x16_bf16 v[48:63], v[96:99], v[120:123], v[16:31]
    ds_read_b128 v[96:99], v3 offset:49152
    v_exp_f32 v36, v36
    v_exp_f32 v37, v37
    v_exp_f32 v38, v38
    ds_read_b64_tr_b16 v[184:185], v7 offset:14336
    ds_read_b64_tr_b16 v[186:187], v7 offset:15360
    ds_read_b64_tr_b16 v[188:189], v8 offset:14336
    ds_read_b64_tr_b16 v[190:191], v8 offset:15360
    s_cmp_lt_u32 s68, 4
    s_cbranch_scc1 Lcn51
    s_setprio 1
Lcn51:
    v_exp_f32 v39, v39
    v_exp_f32 v40, v40
    v_exp_f32 v41, v41
    s_waitcnt lgkmcnt(15)
    v_smfmac_f32_32x32x32_bf16 v[80:95], v[104:107], v[32:39], v5
    v_exp_f32 v42, v42
    v_exp_f32 v43, v43
    v_exp_f32 v44, v44
    v_exp_f32 v45, v45
    v_exp_f32 v46, v46
    v_exp_f32 v47, v47
    v_exp_f32 v48, v48
    v_exp_f32 v49, v49
    v_smfmac_f32_32x32x32_bf16 v[80:95], v[108:111], v[40:47], v5
    v_exp_f32 v50, v50
    v_exp_f32 v51, v51
    v_mfma_f32_32x32x16_bf16 v[32:47], v[100:103], v[124:127], v[16:31]
    v_exp_f32 v52, v52
    v_exp_f32 v53, v53
    v_exp_f32 v54, v54
    s_lshl_b32 s73, s90, 5
    s_add_u32 s73, s73, s88
    s_lshl_b32 s73, s73, 2
    s_add_u32 s73, s73, 0xc1c000
    s_waitcnt vmcnt(0)
    v_mov_b32 v9, 1
    s_mov_b64 exec, 1
    buffer_store_dword v9, off, s[40:43], s73 sc1
    s_mov_b64 exec, -1
    v_exp_f32 v55, v55
    v_exp_f32 v56, v56
    v_exp_f32 v57, v57
    v_smfmac_f32_32x32x32_bf16 v[64:79], v[104:107], v[48:55], v5
    v_exp_f32 v58, v58
    v_exp_f32 v59, v59
    v_exp_f32 v60, v60
    v_exp_f32 v61, v61
    v_exp_f32 v62, v62
    v_exp_f32 v63, v63
    v_exp_f32 v32, v32
    v_exp_f32 v33, v33
    v_smfmac_f32_32x32x32_bf16 v[64:79], v[108:111], v[56:63], v5
    s_mov_b64 exec, s[0:1]
    ds_read_b128 v[104:107], v4 offset:50176
    ds_read_b128 v[108:111], v4 offset:50688
    s_mov_b64 exec, -1
    v_exp_f32 v34, v34
    v_exp_f32 v35, v35
    v_mfma_f32_32x32x16_bf16 v[48:63], v[100:103], v[120:123], v[16:31]
    ds_read_b128 v[100:103], v3 offset:51200
    v_exp_f32 v36, v36
    v_exp_f32 v37, v37
    v_exp_f32 v38, v38
    s_waitcnt lgkmcnt(3)
    s_barrier
    s_lshl_b32 s86, s11, 13
    s_add_u32 s86, s86, s92
    s_add_u32 m0, s86, 0
    s_add_u32 s72, s93, 0
    buffer_load_dwordx4 v6, s[60:63], s72 offen lds
    v_exp_f32 v39, v39
    v_exp_f32 v40, v40
    v_exp_f32 v41, v41
    v_smfmac_f32_32x32x32_bf16 v[80:95], v[112:115], v[32:39], v5
    v_exp_f32 v42, v42
    v_exp_f32 v43, v43
    v_exp_f32 v44, v44
    v_exp_f32 v45, v45
    v_exp_f32 v46, v46
    v_exp_f32 v47, v47
    v_exp_f32 v48, v48
    v_exp_f32 v49, v49
    v_smfmac_f32_32x32x32_bf16 v[80:95], v[116:119], v[40:47], v5
    v_exp_f32 v50, v50
    v_exp_f32 v51, v51
    v_mfma_f32_32x32x16_bf16 v[32:47], v[96:99], v[124:127], v[16:31]
    v_exp_f32 v52, v52
    v_exp_f32 v53, v53
    v_exp_f32 v54, v54
    s_add_u32 m0, s86, 1024
    s_add_u32 s72, s93, 8192
    buffer_load_dwordx4 v6, s[60:63], s72 offen lds
    s_cmp_lt_u32 s68, 4
    s_cbranch_scc1 Lcn52
    s_setprio 0
Lcn52:
    v_exp_f32 v55, v55
    v_exp_f32 v56, v56
    v_exp_f32 v57, v57
    v_smfmac_f32_32x32x32_bf16 v[64:79], v[112:115], v[48:55], v5
    v_exp_f32 v58, v58
    v_exp_f32 v59, v59
    v_exp_f32 v60, v60
    v_exp_f32 v61, v61
    v_exp_f32 v62, v62
    v_exp_f32 v63, v63
    v_exp_f32 v32, v32
    v_exp_f32 v33, v33
    v_smfmac_f32_32x32x32_bf16 v[64:79], v[116:119], v[56:63], v5
    s_mov_b64 exec, s[0:1]
    ds_read_b128 v[112:115], v4 offset:52224
    ds_read_b128 v[116:119], v4 offset:52736
    s_mov_b64 exec, -1
    v_exp_f32 v34, v34
    v_exp_f32 v35, v35
    v_mfma_f32_32x32x16_bf16 v[48:63], v[96:99], v[120:123], v[16:31]
    ds_read_b128 v[96:99], v3 offset:53248
    v_exp_f32 v36, v36
    v_exp_f32 v37, v37
    v_exp_f32 v38, v38
    s_add_u32 m0, s86, 2048
    s_add_u32 s72, s93, 16384
    buffer_load_dwordx4 v6, s[60:63], s72 offen lds
    s_cmp_lt_u32 s68, 4
    s_cbranch_scc1 Lcn53
    s_setprio 1
Lcn53:
    v_exp_f32 v39, v39
    v_exp_f32 v40, v40
    v_exp_f32 v41, v41
    s_waitcnt lgkmcnt(4)
    v_smfmac_f32_32x32x32_bf16 v[80:95], v[104:107], v[32:39], v5
    v_exp_f32 v42, v42
    v_exp_f32 v43, v43
    v_exp_f32 v44, v44
    v_exp_f32 v45, v45
    v_exp_f32 v46, v46
    v_exp_f32 v47, v47
    v_exp_f32 v48, v48
    v_exp_f32 v49, v49
    v_smfmac_f32_32x32x32_bf16 v[80:95], v[108:111], v[40:47], v5
    v_exp_f32 v50, v50
    v_exp_f32 v51, v51
    s_waitcnt lgkmcnt(3)
    v_mfma_f32_32x32x16_bf16 v[32:47], v[100:103], v[124:127], v[16:31]
    v_exp_f32 v52, v52
    v_exp_f32 v53, v53
    v_exp_f32 v54, v54
    s_add_u32 m0, s86, 3072
    s_add_u32 s72, s93, 24576
    buffer_load_dwordx4 v6, s[60:63], s72 offen lds
    v_exp_f32 v55, v55
    v_exp_f32 v56, v56
    v_exp_f32 v57, v57
    v_smfmac_f32_32x32x32_bf16 v[64:79], v[104:107], v[48:55], v5
    v_exp_f32 v58, v58
    v_exp_f32 v59, v59
    v_exp_f32 v60, v60
    v_exp_f32 v61, v61
    v_exp_f32 v62, v62
    v_exp_f32 v63, v63
    v_exp_f32 v32, v32
    v_exp_f32 v33, v33
    v_smfmac_f32_32x32x32_bf16 v[64:79], v[108:111], v[56:63], v5
    s_mov_b64 exec, s[0:1]
    ds_read_b128 v[104:107], v4 offset:54272
    ds_read_b128 v[108:111], v4 offset:54784
    s_mov_b64 exec, -1
    v_exp_f32 v34, v34
    v_exp_f32 v35, v35
    v_mfma_f32_32x32x16_bf16 v[48:63], v[100:103], v[120:123], v[16:31]
    ds_read_b128 v[100:103], v3 offset:55296
    v_exp_f32 v36, v36
    v_exp_f32 v37, v37
    v_exp_f32 v38, v38
    s_add_u32 m0, s86, 4096
    s_add_u32 s72, s93, 32768
    buffer_load_dwordx4 v6, s[60:63], s72 offen lds
    s_lshl_b32 s72, s5, 7
    s_lshl_b32 s73, s90, 7
    s_sub_u32 s73, s73, 128
    v_lshl_add_u32 v10, v1, 2, s72
    s_mov_b32 exec_lo, 0
    v_lshl_add_u32 v10, v1, 2, s73
    s_mov_b32 exec_lo, -1
    s_mov_b32 s8, 0xc1c000
    buffer_load_dword v14, v10, s[40:43], s8 offen sc1
    v_exp_f32 v39, v39
    v_exp_f32 v40, v40
    v_exp_f32 v41, v41
    s_waitcnt lgkmcnt(4)
    v_smfmac_f32_32x32x32_bf16 v[80:95], v[112:115], v[32:39], v5
    v_exp_f32 v42, v42
    v_exp_f32 v43, v43
    v_exp_f32 v44, v44
    v_exp_f32 v45, v45
    v_exp_f32 v46, v46
    v_exp_f32 v47, v47
    v_exp_f32 v48, v48
    v_exp_f32 v49, v49
    v_smfmac_f32_32x32x32_bf16 v[80:95], v[116:119], v[40:47], v5
    v_exp_f32 v50, v50
    v_exp_f32 v51, v51
    s_waitcnt lgkmcnt(3)
    v_mfma_f32_32x32x16_bf16 v[32:47], v[96:99], v[124:127], v[16:31]
    v_exp_f32 v52, v52
    v_exp_f32 v53, v53
    v_exp_f32 v54, v54
    s_add_u32 m0, s86, 5120
    s_add_u32 s72, s93, 40960
    buffer_load_dwordx4 v6, s[60:63], s72 offen lds
    s_cmp_lt_u32 s68, 4
    s_cbranch_scc1 Lcn54
    s_setprio 0
Lcn54:
    v_exp_f32 v55, v55
    v_exp_f32 v56, v56
    v_exp_f32 v57, v57
    v_smfmac_f32_32x32x32_bf16 v[64:79], v[112:115], v[48:55], v5
    v_exp_f32 v58, v58
    v_exp_f32 v59, v59
    v_exp_f32 v60, v60
    v_exp_f32 v61, v61
    v_exp_f32 v62, v62
    v_exp_f32 v63, v63
    v_exp_f32 v32, v32
    v_exp_f32 v33, v33
    v_smfmac_f32_32x32x32_bf16 v[64:79], v[116:119], v[56:63], v5
    s_mov_b64 exec, s[0:1]
    ds_read_b128 v[112:115], v4 offset:56320
    ds_read_b128 v[116:119], v4 offset:56832
    s_mov_b64 exec, -1
    v_exp_f32 v34, v34
    v_exp_f32 v35, v35
    v_mfma_f32_32x32x16_bf16 v[48:63], v[96:99], v[120:123], v[16:31]
    ds_read_b128 v[96:99], v3 offset:57344
    v_exp_f32 v36, v36
    v_exp_f32 v37, v37
    v_exp_f32 v38, v38
    s_add_u32 m0, s86, 6144
    s_add_u32 s72, s93, 49152
    buffer_load_dwordx4 v6, s[60:63], s72 offen lds
    s_cmp_lt_u32 s68, 4
    s_cbranch_scc1 Lcn55
    s_setprio 1
Lcn55:
    v_exp_f32 v39, v39
    v_exp_f32 v40, v40
    v_exp_f32 v41, v41
    s_waitcnt lgkmcnt(4)
    v_smfmac_f32_32x32x32_bf16 v[80:95], v[104:107], v[32:39], v5
    v_exp_f32 v42, v42
    v_exp_f32 v43, v43
    v_exp_f32 v44, v44
    v_exp_f32 v45, v45
    v_exp_f32 v46, v46
    v_exp_f32 v47, v47
    v_exp_f32 v48, v48
    v_exp_f32 v49, v49
    v_smfmac_f32_32x32x32_bf16 v[80:95], v[108:111], v[40:47], v5
    v_exp_f32 v50, v50
    v_exp_f32 v51, v51
    s_waitcnt lgkmcnt(3)
    v_mfma_f32_32x32x16_bf16 v[32:47], v[100:103], v[124:127], v[16:31]
    v_exp_f32 v52, v52
    v_exp_f32 v53, v53
    v_exp_f32 v54, v54
    s_add_u32 m0, s86, 7168
    s_add_u32 s72, s93, 57344
    buffer_load_dwordx4 v6, s[60:63], s72 offen lds
    s_waitcnt vmcnt(3)
    s_mov_b32 s91, 0
Lsp56:
    v_cmp_eq_u32 vcc, 0, v14
    s_nop 0
    s_cbranch_vccz Lsd57
    s_sleep 4
    buffer_load_dword v14, v10, s[40:43], s8 offen sc1
    s_add_u32 s91, s91, 1
    s_cmp_lt_u32 s91, 400000
    s_waitcnt vmcnt(0)
    s_cbranch_scc1 Lsp56
Lsd57:
    v_and_b32 v10, 31, v1
    v_lshlrev_b32 v10, 3, v10
    s_lshl_b32 s72, s5, 8
    s_add_u32 s72, s72, 0xc00000
    s_lshl_b32 s73, s90, 8
    s_add_u32 s73, s73, 0xc00000
    buffer_load_dword v12, v10, s[40:43], s72 offen sc1
    buffer_load_dword v13, v10, s[40:43], s73 offen offset:4 sc1
    s_lshl_b32 s94, s5, 11
    s_lshl_b32 s72, s10, 20
    s_add_u32 s94, s94, s72
    s_lshr_b32 s76, s94, 1
    s_add_u32 s76, s76, 0x400000
    s_add_u32 s94, s94, 0x600000
    v_exp_f32 v55, v55
    v_exp_f32 v56, v56
    v_exp_f32 v57, v57
    v_smfmac_f32_32x32x32_bf16 v[64:79], v[104:107], v[48:55], v5
    v_exp_f32 v58, v58
    v_exp_f32 v59, v59
    v_exp_f32 v60, v60
    v_exp_f32 v61, v61
    v_exp_f32 v62, v62
    v_exp_f32 v63, v63
    v_exp_f32 v32, v32
    v_exp_f32 v33, v33
    v_smfmac_f32_32x32x32_bf16 v[64:79], v[108:111], v[56:63], v5
    s_mov_b64 exec, s[0:1]
    ds_read_b128 v[104:107], v4 offset:58368
    ds_read_b128 v[108:111], v4 offset:58880
    s_mov_b64 exec, -1
    v_exp_f32 v34, v34
    v_exp_f32 v35, v35
    v_mfma_f32_32x32x16_bf16 v[48:63], v[100:103], v[120:123], v[16:31]
    ds_read_b128 v[100:103], v3 offset:59392
    v_exp_f32 v36, v36
    v_exp_f32 v37, v37
    v_exp_f32 v38, v38
    buffer_load_dwordx4 v[192:195], v2, s[40:43], s94 offen sc1
    v_exp_f32 v39, v39
    v_exp_f32 v40, v40
    v_exp_f32 v41, v41
    s_waitcnt lgkmcnt(4)
    v_smfmac_f32_32x32x32_bf16 v[80:95], v[112:115], v[32:39], v5
    v_exp_f32 v42, v42
    v_exp_f32 v43, v43
    v_exp_f32 v44, v44
    v_exp_f32 v45, v45
    v_exp_f32 v46, v46
    v_exp_f32 v47, v47
    v_exp_f32 v48, v48
    v_exp_f32 v49, v49
    v_smfmac_f32_32x32x32_bf16 v[80:95], v[116:119], v[40:47], v5
    v_exp_f32 v50, v50
    v_exp_f32 v51, v51
    s_waitcnt lgkmcnt(3)
    v_mfma_f32_32x32x16_bf16 v[32:47], v[96:99], v[124:127], v[16:31]
    v_exp_f32 v52, v52
    v_exp_f32 v53, v53
    v_exp_f32 v54, v54
    s_add_u32 s94, s94, 0x20000
    buffer_load_dwordx4 v[196:199], v2, s[40:43], s94 offen sc1
    s_cmp_lt_u32 s68, 4
    s_cbranch_scc1 Lcn58
    s_setprio 0
Lcn58:
    v_exp_f32 v55, v55
    v_exp_f32 v56, v56
    v_exp_f32 v57, v57
    v_smfmac_f32_32x32x32_bf16 v[64:79], v[112:115], v[48:55], v5
    v_exp_f32 v58, v58
    v_exp_f32 v59, v59
    v_exp_f32 v60, v60
    v_exp_f32 v61, v61
    v_exp_f32 v62, v62
    v_exp_f32 v63, v63
    v_exp_f32 v32, v32
    v_exp_f32 v33, v33
    v_smfmac_f32_32x32x32_bf16 v[64:79], v[116:119], v[56:63], v5
    s_mov_b64 exec, s[0:1]
    ds_read_b128 v[112:115], v4 offset:60416
    ds_read_b128 v[116:119], v4 offset:60928
    s_mov_b64 exec, -1
    v_exp_f32 v34, v34
    v_exp_f32 v35, v35
    v_mfma_f32_32x32x16_bf16 v[48:63], v[96:99], v[120:123], v[16:31]
    ds_read_b128 v[96:99], v3 offset:61440
    v_exp_f32 v36, v36
    v_exp_f32 v37, v37
    v_exp_f32 v38, v38
    s_add_u32 s94, s94, 0x20000
    buffer_load_dwordx4 v[200:203], v2, s[40:43], s94 offen sc1
    s_cmp_lt_u32 s68, 4
    s_cbranch_scc1 Lcn59
    s_setprio 1
Lcn59:
    v_exp_f32 v39, v39
    v_exp_f32 v40, v40
    v_exp_f32 v41, v41
    s_waitcnt lgkmcnt(4)
    v_smfmac_f32_32x32x32_bf16 v[80:95], v[104:107], v[32:39], v5
    v_exp_f32 v42, v42
    v_exp_f32 v43, v43
    v_exp_f32 v44, v44
    v_exp_f32 v45, v45
    v_exp_f32 v46, v46
    v_exp_f32 v47, v47
    v_exp_f32 v48, v48
    v_exp_f32 v49, v49
    v_smfmac_f32_32x32x32_bf16 v[80:95], v[108:111], v[40:47], v5
    v_exp_f32 v50, v50
    v_exp_f32 v51, v51
    s_waitcnt lgkmcnt(3)
    v_mfma_f32_32x32x16_bf16 v[32:47], v[100:103], v[124:127], v[16:31]
    v_exp_f32 v52, v52
    v_exp_f32 v53, v53
    v_exp_f32 v54, v54
    s_add_u32 s94, s94, 0x20000
    buffer_load_dwordx4 v[204:207], v2, s[40:43], s94 offen sc1
    v_exp_f32 v55, v55
    v_exp_f32 v56, v56
    v_exp_f32 v57, v57
    v_smfmac_f32_32x32x32_bf16 v[64:79], v[104:107], v[48:55], v5
    v_exp_f32 v58, v58
    v_exp_f32 v59, v59
    v_exp_f32 v60, v60
    v_exp_f32 v61, v61
    v_exp_f32 v62, v62
    v_exp_f32 v63, v63
    v_exp_f32 v32, v32
    v_exp_f32 v33, v33
    v_smfmac_f32_32x32x32_bf16 v[64:79], v[108:111], v[56:63], v5
    s_mov_b64 exec, s[0:1]
    ds_read_b128 v[104:107], v4 offset:62464
    ds_read_b128 v[108:111], v4 offset:62976
    s_mov_b64 exec, -1
    v_exp_f32 v34, v34
    v_exp_f32 v35, v35
    v_mfma_f32_32x32x16_bf16 v[48:63], v[100:103], v[120:123], v[16:31]
    ds_read_b128 v[100:103], v3 offset:63488
    v_exp_f32 v36, v36
    v_exp_f32 v37, v37
    v_exp_f32 v38, v38
    s_add_u32 s94, s94, 0x20000
    buffer_load_dwordx4 v[208:211], v2, s[40:43], s94 offen sc1
    v_exp_f32 v39, v39
    v_exp_f32 v40, v40
    v_exp_f32 v41, v41
    s_waitcnt lgkmcnt(4)
    v_smfmac_f32_32x32x32_bf16 v[80:95], v[112:115], v[32:39], v5
    v_exp_f32 v42, v42
    v_exp_f32 v43, v43
    v_exp_f32 v44, v44
    v_exp_f32 v45, v45
    v_exp_f32 v46, v46
    v_exp_f32 v47, v47
    v_exp_f32 v48, v48
    v_exp_f32 v49, v49
    v_smfmac_f32_32x32x32_bf16 v[80:95], v[116:119], v[40:47], v5
    v_exp_f32 v50, v50
    v_exp_f32 v51, v51
    s_waitcnt lgkmcnt(3)
    v_mfma_f32_32x32x16_bf16 v[32:47], v[96:99], v[124:127], v[16:31]
    v_exp_f32 v52, v52
    v_exp_f32 v53, v53
    v_exp_f32 v54, v54
    s_add_u32 s94, s94, 0x20000
    buffer_load_dwordx4 v[212:215], v2, s[40:43], s94 offen sc1
    s_cmp_lt_u32 s68, 4
    s_cbranch_scc1 Lcn60
    s_setprio 0
Lcn60:
    v_exp_f32 v55, v55
    v_exp_f32 v56, v56
    v_exp_f32 v57, v57
    v_smfmac_f32_32x32x32_bf16 v[64:79], v[112:115], v[48:55], v5
    v_exp_f32 v58, v58
    v_exp_f32 v59, v59
    v_exp_f32 v60, v60
    v_exp_f32 v61, v61
    v_exp_f32 v62, v62
    v_exp_f32 v63, v63
    v_exp_f32 v32, v32
    v_exp_f32 v33, v33
    v_smfmac_f32_32x32x32_bf16 v[64:79], v[116:119], v[56:63], v5
    s_mov_b64 exec, s[0:1]
    ds_read_b128 v[112:115], v4 offset:64512
    ds_read_b128 v[116:119], v4 offset:65024
    s_mov_b64 exec, -1
    v_exp_f32 v34, v34
    v_exp_f32 v35, v35
    v_mfma_f32_32x32x16_bf16 v[48:63], v[96:99], v[120:123], v[16:31]
    v_exp_f32 v36, v36
    v_exp_f32 v37, v37
    v_exp_f32 v38, v38
    s_add_u32 s94, s94, 0x20000
    buffer_load_dwordx4 v[216:219], v2, s[40:43], s94 offen sc1
    s_cmp_lt_u32 s68, 4
    s_cbranch_scc1 Lcn61
    s_setprio 1
Lcn61:
    v_exp_f32 v39, v39
    v_exp_f32 v40, v40
    v_exp_f32 v41, v41
    s_waitcnt lgkmcnt(3)
    v_smfmac_f32_32x32x32_bf16 v[80:95], v[104:107], v[32:39], v5
    v_exp_f32 v42, v42
    v_exp_f32 v43, v43
    v_exp_f32 v44, v44
    v_exp_f32 v45, v45
    v_exp_f32 v46, v46
    v_exp_f32 v47, v47
    v_exp_f32 v48, v48
    v_exp_f32 v49, v49
    v_smfmac_f32_32x32x32_bf16 v[80:95], v[108:111], v[40:47], v5
    v_exp_f32 v50, v50
    v_exp_f32 v51, v51
    s_waitcnt lgkmcnt(2)
    v_mfma_f32_32x32x16_bf16 v[32:47], v[100:103], v[124:127], v[16:31]
    v_exp_f32 v52, v52
    v_exp_f32 v53, v53
    v_exp_f32 v54, v54
    s_add_u32 s94, s94, 0x20000
    buffer_load_dwordx4 v[220:223], v2, s[40:43], s94 offen sc1
    v_exp_f32 v55, v55
    v_exp_f32 v56, v56
    v_exp_f32 v57, v57
    v_smfmac_f32_32x32x32_bf16 v[64:79], v[104:107], v[48:55], v5
    v_exp_f32 v58, v58
    v_exp_f32 v59, v59
    v_exp_f32 v60, v60
    v_exp_f32 v61, v61
    v_exp_f32 v62, v62
    v_exp_f32 v63, v63
    v_exp_f32 v32, v32
    v_exp_f32 v33, v33
    v_smfmac_f32_32x32x32_bf16 v[64:79], v[108:111], v[56:63], v5
    v_exp_f32 v34, v34
    v_exp_f32 v35, v35
    v_mfma_f32_32x32x16_bf16 v[48:63], v[100:103], v[120:123], v[16:31]
    v_exp_f32 v36, v36
    v_exp_f32 v37, v37
    v_exp_f32 v38, v38
    s_mul_i32 s72, s95, 3072
    s_add_u32 s72, s72, 18432
    v_add_u32 v9, s72, v3
    v_xor_b32 v10, 0x10000, v9
    v_exp_f32 v39, v39
    v_exp_f32 v40, v40
    v_exp_f32 v41, v41
    s_waitcnt lgkmcnt(0)
    v_smfmac_f32_32x32x32_bf16 v[80:95], v[112:115], v[32:39], v5
    v_exp_f32 v42, v42
    v_exp_f32 v43, v43
    v_exp_f32 v44, v44
    v_exp_f32 v45, v45
    v_exp_f32 v46, v46
    v_exp_f32 v47, v47
    v_exp_f32 v48, v48
    v_exp_f32 v49, v49
    v_smfmac_f32_32x32x32_bf16 v[80:95], v[116:119], v[40:47], v5
    v_exp_f32 v50, v50
    v_exp_f32 v51, v51
    v_exp_f32 v52, v52
    v_exp_f32 v53, v53
    v_exp_f32 v54, v54
    s_cmp_lt_u32 s68, 4
    s_cbranch_scc1 Lcn62
    s_setprio 0
Lcn62:
    v_exp_f32 v55, v55
    v_exp_f32 v56, v56
    v_exp_f32 v57, v57
    v_smfmac_f32_32x32x32_bf16 v[64:79], v[112:115], v[48:55], v5
    v_exp_f32 v58, v58
    v_exp_f32 v59, v59
    v_exp_f32 v60, v60
    ds_write_b128 v9, v[80:83]
    ds_write_b128 v9, v[84:87] offset:1024
    ds_write_b32 v9, v88 offset:2048
    v_exp_f32 v61, v61
    v_exp_f32 v62, v62
    v_exp_f32 v63, v63
    s_nop 3
    v_smfmac_f32_32x32x32_bf16 v[64:79], v[116:119], v[56:63], v5
    s_waitcnt vmcnt(0)
    s_waitcnt lgkmcnt(0)
    s_barrier
    ds_read_b32 v88, v10 offset:2048
    ds_read_b128 v[80:83], v10
    ds_read_b128 v[84:87], v10 offset:1024
    v_mov_b32 v9, 0x53800000
    v_mov_b32 v10, 0x17800000
    v_mov_b32 v11, 0x207
    s_waitcnt lgkmcnt(2)
    s_nop 1
    v_add_f32 v72, v72, v88
    v_cmp_nle_f32 s[96:97], v72, v9
    v_cmp_nge_f32 vcc, v72, v10
    s_waitcnt lgkmcnt(0)
    v_pk_add_f32 v[64:65], v[64:65], v[80:81]
    v_pk_add_f32 v[66:67], v[66:67], v[82:83]
    v_pk_add_f32 v[68:69], v[68:69], v[84:85]
    v_pk_add_f32 v[70:71], v[70:71], v[86:87]
    s_or_b64 s[96:97], s[96:97], vcc
    v_pk_add_f32 v[80:81], v[64:65], v[66:67]
    v_pk_add_f32 v[82:83], v[68:69], v[70:71]
    v_pk_add_f32 v[80:81], v[80:81], v[82:83]
    v_add_f32 v80, v80, v81
    v_cmp_class_f32 vcc, v80, v11
    s_nop 0
    s_or_b64 vcc, s[96:97], vcc
    s_cbranch_vccnz L_FALLBACK
L_FIN:
    v_rcp_f32 v10, v72
    s_nop 1
    v_mul_f32 v11, v10, v13
    v_mul_f32 v10, v10, v13
    v_pk_mul_f32 v[64:65], v[64:65], v[10:11]
    v_pk_mul_f32 v[66:67], v[66:67], v[10:11]
    v_pk_mul_f32 v[68:69], v[68:69], v[10:11]
    v_pk_mul_f32 v[70:71], v[70:71], v[10:11]
    v_mov_b32 v13, v12
    v_cvt_pk_bf16_f32 v120, v64, v65
    v_cvt_pk_bf16_f32 v121, v66, v67
    v_cvt_pk_bf16_f32 v122, v68, v69
    v_cvt_pk_bf16_f32 v123, v70, v71
    v_min_u32 v120, -2, v120
    v_min_u32 v121, -2, v121
    v_min_u32 v122, -2, v122
    v_min_u32 v123, -2, v123
    buffer_store_dwordx4 v[120:123], v2, s[40:43], s101 offen sc1
    s_barrier
    s_add_u32 s72, s76, 0
    buffer_load_dwordx4 v[64:67], v2, s[40:43], s72 offen sc1
    v_mfma_f32_32x32x16_bf16 v[16:31], v[128:131], v[192:195], 0
    ds_read_b64_tr_b16 v[224:225], v7 offset:0
    ds_read_b64_tr_b16 v[226:227], v7 offset:1024
    v_mfma_f32_32x32x16_bf16 v[96:111], v[132:135], v[192:195], 0
    ds_read_b64_tr_b16 v[228:229], v8 offset:0
    ds_read_b64_tr_b16 v[230:231], v8 offset:1024
    s_add_u32 s72, s76, 65536
    buffer_load_dwordx4 v[68:71], v2, s[40:43], s72 offen sc1
    v_mfma_f32_32x32x16_bf16 v[16:31], v[136:139], v[196:199], v[16:31]
    ds_read_b64_tr_b16 v[232:233], v7 offset:2048
    ds_read_b64_tr_b16 v[234:235], v7 offset:3072
    v_mfma_f32_32x32x16_bf16 v[96:111], v[140:143], v[196:199], v[96:111]
    ds_read_b64_tr_b16 v[236:237], v8 offset:2048
    ds_read_b64_tr_b16 v[238:239], v8 offset:3072
    s_add_u32 s72, s76, 131072
    buffer_load_dwordx4 v[72:75], v2, s[40:43], s72 offen sc1
    v_mfma_f32_32x32x16_bf16 v[16:31], v[144:147], v[200:203], v[16:31]
    ds_read_b64_tr_b16 v[240:241], v7 offset:4096
    ds_read_b64_tr_b16 v[242:243], v7 offset:5120
    v_mfma_f32_32x32x16_bf16 v[96:111], v[148:151], v[200:203], v[96:111]
    ds_read_b64_tr_b16 v[244:245], v8 offset:4096
    ds_read_b64_tr_b16 v[246:247], v8 offset:5120
    s_add_u32 s72, s76, 196608
    buffer_load_dwordx4 v[76:79], v2, s[40:43], s72 offen sc1
    v_mfma_f32_32x32x16_bf16 v[16:31], v[152:155], v[204:207], v[16:31]
    ds_read_b64_tr_b16 v[248:249], v7 offset:6144
    ds_read_b64_tr_b16 v[250:251], v7 offset:7168
    v_mfma_f32_32x32x16_bf16 v[96:111], v[156:159], v[204:207], v[96:111]
    ds_read_b64_tr_b16 v[252:253], v8 offset:6144
    ds_read_b64_tr_b16 v[254:255], v8 offset:7168
    s_add_u32 s72, s76, 262144
    buffer_load_dwordx4 v[80:83], v2, s[40:43], s72 offen sc1
    v_mfma_f32_32x32x16_bf16 v[16:31], v[160:163], v[208:211], v[16:31]
    ds_read_b64_tr_b16 v[32:33], v7 offset:8192
    ds_read_b64_tr_b16 v[34:35], v7 offset:9216
    v_mfma_f32_32x32x16_bf16 v[96:111], v[164:167], v[208:211], v[96:111]
    ds_read_b64_tr_b16 v[36:37], v8 offset:8192
    ds_read_b64_tr_b16 v[38:39], v8 offset:9216
    s_add_u32 s72, s76, 327680
    buffer_load_dwordx4 v[84:87], v2, s[40:43], s72 offen sc1
    v_mfma_f32_32x32x16_bf16 v[16:31], v[168:171], v[212:215], v[16:31]
    ds_read_b64_tr_b16 v[40:41], v7 offset:10240
    ds_read_b64_tr_b16 v[42:43], v7 offset:11264
    v_mfma_f32_32x32x16_bf16 v[96:111], v[172:175], v[212:215], v[96:111]
    ds_read_b64_tr_b16 v[44:45], v8 offset:10240
    ds_read_b64_tr_b16 v[46:47], v8 offset:11264
    s_add_u32 s72, s76, 393216
    buffer_load_dwordx4 v[88:91], v2, s[40:43], s72 offen sc1
    v_mfma_f32_32x32x16_bf16 v[16:31], v[176:179], v[216:219], v[16:31]
    ds_read_b64_tr_b16 v[48:49], v7 offset:12288
    ds_read_b64_tr_b16 v[50:51], v7 offset:13312
    v_mfma_f32_32x32x16_bf16 v[96:111], v[180:183], v[216:219], v[96:111]
    ds_read_b64_tr_b16 v[52:53], v8 offset:12288
    ds_read_b64_tr_b16 v[54:55], v8 offset:13312
    s_add_u32 s72, s76, 458752
    buffer_load_dwordx4 v[92:95], v2, s[40:43], s72 offen sc1
    v_mfma_f32_32x32x16_bf16 v[16:31], v[184:187], v[220:223], v[16:31]
    ds_read_b64_tr_b16 v[56:57], v7 offset:14336
    ds_read_b64_tr_b16 v[58:59], v7 offset:15360
    v_mfma_f32_32x32x16_bf16 v[96:111], v[188:191], v[220:223], v[96:111]
    ds_read_b64_tr_b16 v[60:61], v8 offset:14336
    ds_read_b64_tr_b16 v[62:63], v8 offset:15360
    v_and_b32 v9, 31, v1
    s_and_b32 s74, s68, 3
    s_lshl_b32 s74, s74, 5
    v_add_u32 v9, s74, v9
    v_mul_u32_u24 v9, 272, v9
    v_lshrrev_b32 v10, 5, v1
    v_lshl_add_u32 v9, v10, 4, v9
    s_lshr_b32 s74, s68, 2
    s_lshl_b32 s74, s74, 16
    s_add_u32 s74, s74, 30720
    v_add_u32 v9, s74, v9
    v_lshrrev_b32 v10, 3, v0
    v_mul_u32_u24 v11, 272, v10
    v_and_b32 v3, 7, v0
    v_lshl_add_u32 v11, v3, 5, v11
    v_add_u32 v4, 0x10000, v11
    v_lshlrev_b32 v10, 10, v10
    v_lshl_add_u32 v10, v3, 4, v10
    s_lshr_b32 s74, s5, 1
    s_lshl_b32 s74, s74, 16
    s_lshl_b32 s75, s4, 7
    s_add_u32 s74, s74, s75
    v_pk_mul_f32 v[16:17], v[16:17], v[12:13]
    v_pk_mul_f32 v[18:19], v[18:19], v[12:13]
    v_pk_mul_f32 v[20:21], v[20:21], v[12:13]
    v_pk_mul_f32 v[22:23], v[22:23], v[12:13]
    v_pk_mul_f32 v[24:25], v[24:25], v[12:13]
    v_pk_mul_f32 v[26:27], v[26:27], v[12:13]
    v_pk_mul_f32 v[28:29], v[28:29], v[12:13]
    v_pk_mul_f32 v[30:31], v[30:31], v[12:13]
    v_pk_mul_f32 v[96:97], v[96:97], v[12:13]
    v_pk_mul_f32 v[98:99], v[98:99], v[12:13]
    v_pk_mul_f32 v[100:101], v[100:101], v[12:13]
    v_pk_mul_f32 v[102:103], v[102:103], v[12:13]
    v_pk_mul_f32 v[104:105], v[104:105], v[12:13]
    v_pk_mul_f32 v[106:107], v[106:107], v[12:13]
    v_pk_mul_f32 v[108:109], v[108:109], v[12:13]
    v_pk_mul_f32 v[110:111], v[110:111], v[12:13]
    s_mov_b32 s91, 0
    s_waitcnt lgkmcnt(0)
    s_waitcnt vmcnt(7)
L_OBC0:
    v_max3_u32 v3, v64, v65, v66
    v_max_u32 v3, v67, v3
    v_cmp_eq_u32 vcc, -1, v3
    s_nop 0
    s_cbranch_vccnz L_OBR0
L_OBY0:
    v_mfma_f32_32x32x16_bf16 v[16:31], v[224:227], v[64:67], v[16:31]
    v_mfma_f32_32x32x16_bf16 v[96:111], v[228:231], v[64:67], v[96:111]
    s_waitcnt vmcnt(6)
L_OBC1:
    v_max3_u32 v3, v68, v69, v70
    v_max_u32 v3, v71, v3
    v_cmp_eq_u32 vcc, -1, v3
    s_nop 0
    s_cbranch_vccnz L_OBR1
L_OBY1:
    v_mfma_f32_32x32x16_bf16 v[16:31], v[232:235], v[68:71], v[16:31]
    v_mfma_f32_32x32x16_bf16 v[96:111], v[236:239], v[68:71], v[96:111]
    s_waitcnt vmcnt(5)
L_OBC2:
    v_max3_u32 v3, v72, v73, v74
    v_max_u32 v3, v75, v3
    v_cmp_eq_u32 vcc, -1, v3
    s_nop 0
    s_cbranch_vccnz L_OBR2
L_OBY2:
    v_mfma_f32_32x32x16_bf16 v[16:31], v[240:243], v[72:75], v[16:31]
    v_mfma_f32_32x32x16_bf16 v[96:111], v[244:247], v[72:75], v[96:111]
    s_waitcnt vmcnt(4)
L_OBC3:
    v_max3_u32 v3, v76, v77, v78
    v_max_u32 v3, v79, v3
    v_cmp_eq_u32 vcc, -1, v3
    s_nop 0
    s_cbranch_vccnz L_OBR3
L_OBY3:
    v_mfma_f32_32x32x16_bf16 v[16:31], v[248:251], v[76:79], v[16:31]
    v_mfma_f32_32x32x16_bf16 v[96:111], v[252:255], v[76:79], v[96:111]
    s_waitcnt vmcnt(3)
L_OBC4:
    v_max3_u32 v3, v80, v81, v82
    v_max_u32 v3, v83, v3
    v_cmp_eq_u32 vcc, -1, v3
    s_nop 0
    s_cbranch_vccnz L_OBR4
L_OBY4:
    v_mfma_f32_32x32x16_bf16 v[16:31], v[32:35], v[80:83], v[16:31]
    v_mfma_f32_32x32x16_bf16 v[96:111], v[36:39], v[80:83], v[96:111]
    s_waitcnt vmcnt(2)
L_OBC5:
    v_max3_u32 v3, v84, v85, v86
    v_max_u32 v3, v87, v3
    v_cmp_eq_u32 vcc, -1, v3
    s_nop 0
    s_cbranch_vccnz L_OBR5
L_OBY5:
    v_mfma_f32_32x32x16_bf16 v[16:31], v[40:43], v[84:87], v[16:31]
    v_mfma_f32_32x32x16_bf16 v[96:111], v[44:47], v[84:87], v[96:111]
    s_waitcnt vmcnt(1)
L_OBC6:
    v_max3_u32 v3, v88, v89, v90
    v_max_u32 v3, v91, v3
    v_cmp_eq_u32 vcc, -1, v3
    s_nop 0
    s_cbranch_vccnz L_OBR6
L_OBY6:
    v_mfma_f32_32x32x16_bf16 v[16:31], v[48:51], v[88:91], v[16:31]
    v_mfma_f32_32x32x16_bf16 v[96:111], v[52:55], v[88:91], v[96:111]
    s_waitcnt vmcnt(0)
L_OBC7:
    v_max3_u32 v3, v92, v93, v94
    v_max_u32 v3, v95, v3
    v_cmp_eq_u32 vcc, -1, v3
    s_nop 0
    s_cbranch_vccnz L_OBR7
L_OBY7:
    v_mfma_f32_32x32x16_bf16 v[16:31], v[56:59], v[92:95], v[16:31]
    v_mfma_f32_32x32x16_bf16 v[96:111], v[60:63], v[92:95], v[96:111]
    s_nop 10
L_OBD:
    ds_write_b128 v9, v[16:19] offset:0
    ds_write_b128 v9, v[20:23] offset:32
    ds_write_b128 v9, v[24:27] offset:64
    ds_write_b128 v9, v[28:31] offset:96
    ds_write_b128 v9, v[96:99] offset:128
    ds_write_b128 v9, v[100:103] offset:160
    ds_write_b128 v9, v[104:107] offset:192
    ds_write_b128 v9, v[108:111] offset:224
    s_waitcnt lgkmcnt(0)
    s_barrier
    ds_read_b128 v[128:131], v11 offset:30720
    ds_read_b128 v[132:135], v11 offset:30736
    ds_read_b128 v[136:139], v11 offset:48128
    ds_read_b128 v[140:143], v11 offset:48144
    ds_read_b128 v[144:147], v4 offset:30720
    ds_read_b128 v[148:151], v4 offset:30736
    ds_read_b128 v[152:155], v4 offset:48128
    ds_read_b128 v[156:159], v4 offset:48144
    s_waitcnt lgkmcnt(4)
    v_pk_add_f32 v[128:129], v[128:129], v[136:137]
    v_pk_add_f32 v[130:131], v[130:131], v[138:139]
    v_pk_add_f32 v[132:133], v[132:133], v[140:141]
    v_pk_add_f32 v[134:135], v[134:135], v[142:143]
    s_waitcnt lgkmcnt(0)
    v_pk_add_f32 v[144:145], v[144:145], v[152:153]
    v_pk_add_f32 v[146:147], v[146:147], v[154:155]
    v_pk_add_f32 v[148:149], v[148:149], v[156:157]
    v_pk_add_f32 v[150:151], v[150:151], v[158:159]
    v_pk_add_f32 v[128:129], v[128:129], v[144:145]
    v_pk_add_f32 v[130:131], v[130:131], v[146:147]
    v_pk_add_f32 v[132:133], v[132:133], v[148:149]
    v_pk_add_f32 v[134:135], v[134:135], v[150:151]
    v_cvt_pk_bf16_f32 v128, v128, v129
    v_cvt_pk_bf16_f32 v129, v130, v131
    v_cvt_pk_bf16_f32 v130, v132, v133
    v_cvt_pk_bf16_f32 v131, v134, v135
    buffer_store_dwordx4 v[128:131], v10, s[64:67], s74 offen sc1
L_END:
    s_endpgm
L_OBR0:
    s_waitcnt vmcnt(0)
    s_add_u32 s72, s76, 0
    buffer_load_dwordx4 v[64:67], v2, s[40:43], s72 offen sc1
    v_max3_u32 v3, v68, v69, v70
    v_max_u32 v3, v71, v3
    v_cmp_eq_u32 vcc, -1, v3
    s_nop 0
    s_cbranch_vccz Los63
    s_add_u32 s72, s76, 65536
    buffer_load_dwordx4 v[68:71], v2, s[40:43], s72 offen sc1
Los63:
    v_max3_u32 v3, v72, v73, v74
    v_max_u32 v3, v75, v3
    v_cmp_eq_u32 vcc, -1, v3
    s_nop 0
    s_cbranch_vccz Los64
    s_add_u32 s72, s76, 131072
    buffer_load_dwordx4 v[72:75], v2, s[40:43], s72 offen sc1
Los64:
    v_max3_u32 v3, v76, v77, v78
    v_max_u32 v3, v79, v3
    v_cmp_eq_u32 vcc, -1, v3
    s_nop 0
    s_cbranch_vccz Los65
    s_add_u32 s72, s76, 196608
    buffer_load_dwordx4 v[76:79], v2, s[40:43], s72 offen sc1
Los65:
    v_max3_u32 v3, v80, v81, v82
    v_max_u32 v3, v83, v3
    v_cmp_eq_u32 vcc, -1, v3
    s_nop 0
    s_cbranch_vccz Los66
    s_add_u32 s72, s76, 262144
    buffer_load_dwordx4 v[80:83], v2, s[40:43], s72 offen sc1
Los66:
    v_max3_u32 v3, v84, v85, v86
    v_max_u32 v3, v87, v3
    v_cmp_eq_u32 vcc, -1, v3
    s_nop 0
    s_cbranch_vccz Los67
    s_add_u32 s72, s76, 327680
    buffer_load_dwordx4 v[84:87], v2, s[40:43], s72 offen sc1
Los67:
    v_max3_u32 v3, v88, v89, v90
    v_max_u32 v3, v91, v3
    v_cmp_eq_u32 vcc, -1, v3
    s_nop 0
    s_cbranch_vccz Los68
    s_add_u32 s72, s76, 393216
    buffer_load_dwordx4 v[88:91], v2, s[40:43], s72 offen sc1
Los68:
    v_max3_u32 v3, v92, v93, v94
    v_max_u32 v3, v95, v3
    v_cmp_eq_u32 vcc, -1, v3
    s_nop 0
    s_cbranch_vccz Los69
    s_add_u32 s72, s76, 458752
    buffer_load_dwordx4 v[92:95], v2, s[40:43], s72 offen sc1
Los69:
    s_add_u32 s91, s91, 1
    s_cmp_lt_u32 s91, 400000
    s_waitcnt vmcnt(0)
    s_cbranch_scc1 L_OBC0
    s_branch L_OBY0
L_OBR1:
    s_waitcnt vmcnt(0)
    s_add_u32 s72, s76, 65536
    buffer_load_dwordx4 v[68:71], v2, s[40:43], s72 offen sc1
    v_max3_u32 v3, v72, v73, v74
    v_max_u32 v3, v75, v3
    v_cmp_eq_u32 vcc, -1, v3
    s_nop 0
    s_cbranch_vccz Los70
    s_add_u32 s72, s76, 131072
    buffer_load_dwordx4 v[72:75], v2, s[40:43], s72 offen sc1
Los70:
    v_max3_u32 v3, v76, v77, v78
    v_max_u32 v3, v79, v3
    v_cmp_eq_u32 vcc, -1, v3
    s_nop 0
    s_cbranch_vccz Los71
    s_add_u32 s72, s76, 196608
    buffer_load_dwordx4 v[76:79], v2, s[40:43], s72 offen sc1
Los71:
    v_max3_u32 v3, v80, v81, v82
    v_max_u32 v3, v83, v3
    v_cmp_eq_u32 vcc, -1, v3
    s_nop 0
    s_cbranch_vccz Los72
    s_add_u32 s72, s76, 262144
    buffer_load_dwordx4 v[80:83], v2, s[40:43], s72 offen sc1
Los72:
    v_max3_u32 v3, v84, v85, v86
    v_max_u32 v3, v87, v3
    v_cmp_eq_u32 vcc, -1, v3
    s_nop 0
    s_cbranch_vccz Los73
    s_add_u32 s72, s76, 327680
    buffer_load_dwordx4 v[84:87], v2, s[40:43], s72 offen sc1
Los73:
    v_max3_u32 v3, v88, v89, v90
    v_max_u32 v3, v91, v3
    v_cmp_eq_u32 vcc, -1, v3
    s_nop 0
    s_cbranch_vccz Los74
    s_add_u32 s72, s76, 393216
    buffer_load_dwordx4 v[88:91], v2, s[40:43], s72 offen sc1
Los74:
    v_max3_u32 v3, v92, v93, v94
    v_max_u32 v3, v95, v3
    v_cmp_eq_u32 vcc, -1, v3
    s_nop 0
    s_cbranch_vccz Los75
    s_add_u32 s72, s76, 458752
    buffer_load_dwordx4 v[92:95], v2, s[40:43], s72 offen sc1
Los75:
    s_add_u32 s91, s91, 1
    s_cmp_lt_u32 s91, 400000
    s_waitcnt vmcnt(0)
    s_cbranch_scc1 L_OBC1
    s_branch L_OBY1
L_OBR2:
    s_waitcnt vmcnt(0)
    s_add_u32 s72, s76, 131072
    buffer_load_dwordx4 v[72:75], v2, s[40:43], s72 offen sc1
    v_max3_u32 v3, v76, v77, v78
    v_max_u32 v3, v79, v3
    v_cmp_eq_u32 vcc, -1, v3
    s_nop 0
    s_cbranch_vccz Los76
    s_add_u32 s72, s76, 196608
    buffer_load_dwordx4 v[76:79], v2, s[40:43], s72 offen sc1
Los76:
    v_max3_u32 v3, v80, v81, v82
    v_max_u32 v3, v83, v3
    v_cmp_eq_u32 vcc, -1, v3
    s_nop 0
    s_cbranch_vccz Los77
    s_add_u32 s72, s76, 262144
    buffer_load_dwordx4 v[80:83], v2, s[40:43], s72 offen sc1
Los77:
    v_max3_u32 v3, v84, v85, v86
    v_max_u32 v3, v87, v3
    v_cmp_eq_u32 vcc, -1, v3
    s_nop 0
    s_cbranch_vccz Los78
    s_add_u32 s72, s76, 327680
    buffer_load_dwordx4 v[84:87], v2, s[40:43], s72 offen sc1
Los78:
    v_max3_u32 v3, v88, v89, v90
    v_max_u32 v3, v91, v3
    v_cmp_eq_u32 vcc, -1, v3
    s_nop 0
    s_cbranch_vccz Los79
    s_add_u32 s72, s76, 393216
    buffer_load_dwordx4 v[88:91], v2, s[40:43], s72 offen sc1
Los79:
    v_max3_u32 v3, v92, v93, v94
    v_max_u32 v3, v95, v3
    v_cmp_eq_u32 vcc, -1, v3
    s_nop 0
    s_cbranch_vccz Los80
    s_add_u32 s72, s76, 458752
    buffer_load_dwordx4 v[92:95], v2, s[40:43], s72 offen sc1
Los80:
    s_add_u32 s91, s91, 1
    s_cmp_lt_u32 s91, 400000
    s_waitcnt vmcnt(0)
    s_cbranch_scc1 L_OBC2
    s_branch L_OBY2
L_OBR3:
    s_waitcnt vmcnt(0)
    s_add_u32 s72, s76, 196608
    buffer_load_dwordx4 v[76:79], v2, s[40:43], s72 offen sc1
    v_max3_u32 v3, v80, v81, v82
    v_max_u32 v3, v83, v3
    v_cmp_eq_u32 vcc, -1, v3
    s_nop 0
    s_cbranch_vccz Los81
    s_add_u32 s72, s76, 262144
    buffer_load_dwordx4 v[80:83], v2, s[40:43], s72 offen sc1
Los81:
    v_max3_u32 v3, v84, v85, v86
    v_max_u32 v3, v87, v3
    v_cmp_eq_u32 vcc, -1, v3
    s_nop 0
    s_cbranch_vccz Los82
    s_add_u32 s72, s76, 327680
    buffer_load_dwordx4 v[84:87], v2, s[40:43], s72 offen sc1
Los82:
    v_max3_u32 v3, v88, v89, v90
    v_max_u32 v3, v91, v3
    v_cmp_eq_u32 vcc, -1, v3
    s_nop 0
    s_cbranch_vccz Los83
    s_add_u32 s72, s76, 393216
    buffer_load_dwordx4 v[88:91], v2, s[40:43], s72 offen sc1
Los83:
    v_max3_u32 v3, v92, v93, v94
    v_max_u32 v3, v95, v3
    v_cmp_eq_u32 vcc, -1, v3
    s_nop 0
    s_cbranch_vccz Los84
    s_add_u32 s72, s76, 458752
    buffer_load_dwordx4 v[92:95], v2, s[40:43], s72 offen sc1
Los84:
    s_add_u32 s91, s91, 1
    s_cmp_lt_u32 s91, 400000
    s_waitcnt vmcnt(0)
    s_cbranch_scc1 L_OBC3
    s_branch L_OBY3
L_OBR4:
    s_waitcnt vmcnt(0)
    s_add_u32 s72, s76, 262144
    buffer_load_dwordx4 v[80:83], v2, s[40:43], s72 offen sc1
    v_max3_u32 v3, v84, v85, v86
    v_max_u32 v3, v87, v3
    v_cmp_eq_u32 vcc, -1, v3
    s_nop 0
    s_cbranch_vccz Los85
    s_add_u32 s72, s76, 327680
    buffer_load_dwordx4 v[84:87], v2, s[40:43], s72 offen sc1
Los85:
    v_max3_u32 v3, v88, v89, v90
    v_max_u32 v3, v91, v3
    v_cmp_eq_u32 vcc, -1, v3
    s_nop 0
    s_cbranch_vccz Los86
    s_add_u32 s72, s76, 393216
    buffer_load_dwordx4 v[88:91], v2, s[40:43], s72 offen sc1
Los86:
    v_max3_u32 v3, v92, v93, v94
    v_max_u32 v3, v95, v3
    v_cmp_eq_u32 vcc, -1, v3
    s_nop 0
    s_cbranch_vccz Los87
    s_add_u32 s72, s76, 458752
    buffer_load_dwordx4 v[92:95], v2, s[40:43], s72 offen sc1
Los87:
    s_add_u32 s91, s91, 1
    s_cmp_lt_u32 s91, 400000
    s_waitcnt vmcnt(0)
    s_cbranch_scc1 L_OBC4
    s_branch L_OBY4
L_OBR5:
    s_waitcnt vmcnt(0)
    s_add_u32 s72, s76, 327680
    buffer_load_dwordx4 v[84:87], v2, s[40:43], s72 offen sc1
    v_max3_u32 v3, v88, v89, v90
    v_max_u32 v3, v91, v3
    v_cmp_eq_u32 vcc, -1, v3
    s_nop 0
    s_cbranch_vccz Los88
    s_add_u32 s72, s76, 393216
    buffer_load_dwordx4 v[88:91], v2, s[40:43], s72 offen sc1
Los88:
    v_max3_u32 v3, v92, v93, v94
    v_max_u32 v3, v95, v3
    v_cmp_eq_u32 vcc, -1, v3
    s_nop 0
    s_cbranch_vccz Los89
    s_add_u32 s72, s76, 458752
    buffer_load_dwordx4 v[92:95], v2, s[40:43], s72 offen sc1
Los89:
    s_add_u32 s91, s91, 1
    s_cmp_lt_u32 s91, 400000
    s_waitcnt vmcnt(0)
    s_cbranch_scc1 L_OBC5
    s_branch L_OBY5
L_OBR6:
    s_waitcnt vmcnt(0)
    s_add_u32 s72, s76, 393216
    buffer_load_dwordx4 v[88:91], v2, s[40:43], s72 offen sc1
    v_max3_u32 v3, v92, v93, v94
    v_max_u32 v3, v95, v3
    v_cmp_eq_u32 vcc, -1, v3
    s_nop 0
    s_cbranch_vccz Los90
    s_add_u32 s72, s76, 458752
    buffer_load_dwordx4 v[92:95], v2, s[40:43], s72 offen sc1
Los90:
    s_add_u32 s91, s91, 1
    s_cmp_lt_u32 s91, 400000
    s_waitcnt vmcnt(0)
    s_cbranch_scc1 L_OBC6
    s_branch L_OBY6
L_OBR7:
    s_waitcnt vmcnt(0)
    s_add_u32 s72, s76, 458752
    buffer_load_dwordx4 v[92:95], v2, s[40:43], s72 offen sc1
    s_add_u32 s91, s91, 1
    s_cmp_lt_u32 s91, 400000
    s_waitcnt vmcnt(0)
    s_cbranch_scc1 L_OBC7
    s_branch L_OBY7
L_FALLBACK:
    v_and_b32 v4, 0xffff, v4
    v_mov_b32 v9, 0xff800000
    s_mov_b32 s91, 0
    s_lshl_b32 s72, s88, 17
L_FB_MAX:
    buffer_load_dwordx4 v[96:99], v2, s[40:43], s72 offen sc1
    s_waitcnt vmcnt(0)
    v_mfma_f32_32x32x16_bf16 v[80:95], v[96:99], v[120:123], 0
    s_nop 11
    v_max3_f32 v9, v80, v81, v9
    v_max3_f32 v9, v82, v83, v9
    v_max3_f32 v9, v84, v85, v9
    v_max3_f32 v9, v86, v87, v9
    v_max3_f32 v9, v88, v89, v9
    v_max3_f32 v9, v90, v91, v9
    v_max3_f32 v9, v92, v93, v9
    v_max3_f32 v9, v94, v95, v9
    s_add_u32 s72, s72, 2048
    s_add_u32 s91, s91, 1
    s_cmp_lt_u32 s91, 64
    s_cbranch_scc1 L_FB_MAX
    s_mov_b32 s91, 0
    s_lshl_b32 s72, s88, 17
    v_mov_b32 v10, v9
    s_nop 1
    v_permlane32_swap_b32 v9, v10
    v_max_f32 v9, v9, v10
    v_sub_f32 v16, 0, v9
    v_sub_f32 v17, 0, v9
    v_mov_b64 v[18:19], v[16:17]
    v_mov_b64 v[20:21], v[16:17]
    v_mov_b64 v[22:23], v[16:17]
    v_mov_b64 v[24:25], v[16:17]
    v_mov_b64 v[26:27], v[16:17]
    v_mov_b64 v[28:29], v[16:17]
    v_mov_b64 v[30:31], v[16:17]
    v_mov_b32 v64, 0
    v_mov_b32 v65, 0
    v_mov_b32 v66, 0
    v_mov_b32 v67, 0
    v_mov_b32 v68, 0
    v_mov_b32 v69, 0
    v_mov_b32 v70, 0
    v_mov_b32 v71, 0
    v_mov_b32 v72, 0
    v_mov_b32 v73, 0
    v_mov_b32 v74, 0
    v_mov_b32 v75, 0
    v_mov_b32 v76, 0
    v_mov_b32 v77, 0
    v_mov_b32 v78, 0
    v_mov_b32 v79, 0
L_FB_LOOP:
    buffer_load_dwordx4 v[96:99], v2, s[40:43], s72 offen sc1
    s_mov_b64 exec, s[0:1]
    buffer_load_dwordx4 v[104:107], v4, s[40:43], s72 offen offset:1024 sc1
    buffer_load_dwordx4 v[108:111], v4, s[40:43], s72 offen offset:1536 sc1
    s_mov_b64 exec, -1
    s_waitcnt vmcnt(0)
    v_mfma_f32_32x32x16_bf16 v[80:95], v[96:99], v[120:123], v[16:31]
    s_nop 11
    v_exp_f32 v80, v80
    v_exp_f32 v81, v81
    v_exp_f32 v82, v82
    v_exp_f32 v83, v83
    v_exp_f32 v84, v84
    v_exp_f32 v85, v85
    v_exp_f32 v86, v86
    v_exp_f32 v87, v87
    v_exp_f32 v88, v88
    v_exp_f32 v89, v89
    v_exp_f32 v90, v90
    v_exp_f32 v91, v91
    v_exp_f32 v92, v92
    v_exp_f32 v93, v93
    v_exp_f32 v94, v94
    v_exp_f32 v95, v95
    v_smfmac_f32_32x32x32_bf16 v[64:79], v[104:107], v[80:87], v5
    s_nop 2
    v_smfmac_f32_32x32x32_bf16 v[64:79], v[108:111], v[88:95], v5
    s_add_u32 s72, s72, 2048
    s_add_u32 s91, s91, 1
    s_cmp_lt_u32 s91, 64
    s_cbranch_scc1 L_FB_LOOP
    s_nop 6
    s_branch L_FIN
CODE_END:
.set CODE_SPAN, CODE_END - L_PC - 4
.section .rodata,"a"
.p2align 6
.amdhsa_kernel gated_mix__linear_kernel_hedgehog__mha_block__prompt_kernel
  .amdhsa_next_free_vgpr 256
  .amdhsa_next_free_sgpr 102
  .amdhsa_accum_offset 256
  .amdhsa_group_segment_fixed_size 0
  .amdhsa_kernarg_size 88
  .amdhsa_user_sgpr_count 2
  .amdhsa_user_sgpr_kernarg_segment_ptr 1
  .amdhsa_system_sgpr_workgroup_id_x 1
.end_amdhsa_kernel
```
